```python
import torch

def _softmax(x, axis=-1):
    return torch.softmax(x, dim=axis)
def _gelu(x):
    return torch.nn.functional.gelu(x, approximate="tanh")
def _silu(x):
    return torch.nn.functional.silu(x)
def _sigmoid(x):
    return torch.sigmoid(x)
def _layernorm(x, axis=-1, eps=1e-5):
    m = x.mean(dim=axis, keepdim=True)
    v = x.var(dim=axis, keepdim=True, unbiased=False)
    return (x - m) / torch.sqrt(v + eps)
def _scatter_add(tgt, idx, src, axis=0):
    return tgt.clone().index_add_(axis, idx, src)
def _segment_sum(src, seg, n):
    out = torch.zeros((n,) + src.shape[1:], dtype=src.dtype)
    return out.index_add_(0, seg, src)
def _pad(x, pw):
    flat = tuple(v for pair in reversed(pw) for v in pair)
    return torch.nn.functional.pad(x, flat)

kernel_name = 'interleave_layers__mha_block__dense_activation_silu__prompt'

def setup_inputs():

    _w = (lambda a: (lambda t: t.to(torch.bfloat16) if t.is_floating_point() else t)(torch.as_tensor(a)))
    def _A_setup():
        B, S, D, H = 1, 2048, 640, 32
        return {
            "x": _w((lambda *s: torch.randn(*s, dtype=torch.bfloat16) * 0.05)(B, S, D)),
            "wqkv": _w((lambda *s: torch.randn(*s, dtype=torch.bfloat16) * 0.05)(D, 3 * D)),
            "wo": _w((lambda *s: torch.randn(*s, dtype=torch.bfloat16) * 0.05)(D, D)),
        }
    _A_in = _A_setup()

    def _B_setup():
        B, S, D, F = 1, 2048, 640, 1728
        return {
            "x": _w((lambda *s: torch.randn(*s, dtype=torch.bfloat16) * 0.05)(B, S, D)),
            "w1": _w((lambda *s: torch.randn(*s, dtype=torch.bfloat16) * 0.8)(D, F) * (D ** -0.5)),
            "w2": _w((lambda *s: torch.randn(*s, dtype=torch.bfloat16) * 0.8)(F, D) * (F ** -0.5)),
        }
    _B_in = _B_setup()

    return {
        "A_x": _A_in["x"],
        "A_wqkv": _A_in["wqkv"],
        "A_wo": _A_in["wo"],
        "B_x": _B_in["x"],
        "B_w1": _B_in["w1"],
        "B_w2": _B_in["w2"],
    }

def reference(A_x, A_wqkv, A_wo, B_x, B_w1, B_w2):
    def _A_ref(x, wqkv, wo):
        B, S, D = x.shape
        H = 32
        Dh = D // H
        qkv = (lambda x, *d: x.permute(*d))((x @ wqkv).reshape(B, S, 3, H, Dh), 2, 0, 3, 1, 4)
        q, k, v = qkv[0], qkv[1], qkv[2]
        scores = torch.einsum("bhqd,bhkd->bhqk", q, k) * (Dh ** -0.5)
        p = _softmax(scores, axis=-1)
        o = torch.einsum("bhqk,bhkd->bhqd", p, v)
        return (lambda x, *d: x.permute(*d))(o, 0, 2, 1, 3).reshape(B, S, D) @ wo

    def _B_ref(x, w1, w2):
        h = torch.einsum("bsd,df->bsf", x, w1)
        h = _silu(h)
        out = torch.einsum("bsf,fd->bsd", h, w2)
        return out

    x = A_x
    x = x + _A_ref(_layernorm(x, axis=-1), A_wqkv, A_wo)
    x = x + _B_ref(_layernorm(x, axis=-1), B_w1, B_w2)
    x = x + _A_ref(_layernorm(x, axis=-1), A_wqkv, A_wo)
    x = x + _B_ref(_layernorm(x, axis=-1), B_w1, B_w2)
    return x
```

```asm
; @launch grid=(256,1,1) block=(512,1,1) lds=163840
.amdgcn_target "amdgcn-amd-amdhsa--gfx950"
.text
.globl interleave_layers__mha_block__dense_activation_silu__prompt_kernel
.p2align 8
.type interleave_layers__mha_block__dense_activation_silu__prompt_kernel,@function
interleave_layers__mha_block__dense_activation_silu__prompt_kernel:
    s_load_dwordx2 s[4:5], s[0:1], 64
    s_cmp_ge_u32 s2, 256
    s_cbranch_scc1 L_end
    v_lshrrev_b32 v4, 6, v0
    v_and_b32 v1, 63, v0
    v_readfirstlane_b32 s3, v4
    v_lshrrev_b32 v2, 5, v1
    v_and_b32 v3, 31, v1
    s_mov_b32 s7, 0
    s_mov_b32 s101, 0x7f000000
    s_mov_b32 s91, 0
    s_and_b32 s100, s3, 3
    s_waitcnt lgkmcnt(0)
    s_add_u32 s96, s4, 0x3800000
    s_addc_u32 s97, s5, 0
    s_mov_b32 s98, 2162688
    s_mov_b32 s99, 0x20000
    v_mov_b32 v244, s101
    v_mov_b32 v245, s101
    v_mov_b32 v246, s101
    v_mov_b32 v247, s101
    v_mov_b32 v252, s101
    s_mov_b32 s94, 0
    s_mov_b32 s6, 0
    s_cmp_ge_u32 s3, 4
    s_cbranch_scc1 L_loader
    s_load_dwordx2 s[8:9], s[0:1], 0
    s_load_dwordx2 s[12:13], s[0:1], 16
    s_load_dwordx2 s[18:19], s[0:1], 40
    s_load_dwordx2 s[10:11], s[0:1], 56
    s_lshr_b32 s64, s2, 2
    s_and_b32 s65, s2, 3
    s_lshl_b32 s66, s64, 5
    v_add_u32 v5, s66, v3
    v_mul_u32_u24 v5, 1280, v5
    v_lshlrev_b32 v6, 4, v2
    v_add_u32 v5, v5, v6
    s_mul_i32 s66, s65, 320
    s_lshl_b32 s67, s3, 5
    s_add_u32 s66, s66, s67
    v_add_u32 v5, s66, v5
    s_cmp_lt_u32 s3, 2
    s_cselect_b32 s82, 256, s101
    s_lshl_b32 s66, s2, 12
    v_lshlrev_b32 v7, 4, v0
    v_add_u32 v7, s66, v7
    s_waitcnt lgkmcnt(0)
    s_mov_b32 s20, s8
    s_mov_b32 s21, s9
    s_mov_b32 s22, 2621440
    s_mov_b32 s23, 0x20000
    buffer_load_dwordx4 v[8:11], v5, s[20:23], 0 offen
    buffer_load_dwordx4 v[12:15], v5, s[20:23], 0 offen offset:128
    buffer_load_dwordx4 v[16:19], v5, s[20:23], s82 offen
    s_mov_b32 s32, s12
    s_mov_b32 s33, s13
    s_mov_b32 s34, 819200
    s_mov_b32 s35, 0x20000
    s_mov_b32 s36, s18
    s_mov_b32 s37, s19
    s_mov_b32 s38, 2211840
    s_mov_b32 s39, 0x20000
    s_add_u32 s24, s4, 0x0
    s_addc_u32 s25, s5, 0
    s_mov_b32 s26, 2621440
    s_mov_b32 s27, 0x20000
    s_add_u32 s28, s4, 0xa00000
    s_addc_u32 s29, s5, 0
    s_mov_b32 s30, 262144
    s_mov_b32 s31, 0x20000
    s_add_u32 s48, s4, 0xb40000
    s_addc_u32 s49, s5, 0
    s_mov_b32 s50, 819200
    s_mov_b32 s51, 0x20000
    s_add_u32 s52, s4, 0xc40000
    s_addc_u32 s53, s5, 0
    s_mov_b32 s54, 2211840
    s_mov_b32 s55, 0x20000
    s_mul_i32 s70, s3, 2560
    s_add_u32 s70, s70, 135168
    s_lshl_b32 s71, s2, 2
    s_add_u32 s71, s71, s3
    s_cmp_ge_u32 s71, 320
    s_cbranch_scc1 L_pk2_1
    s_mul_i32 s72, s71, 1639
    s_lshr_b32 s72, s72, 16
    s_mul_i32 s73, s72, 40
    s_sub_u32 s73, s71, s73
    s_mul_i32 s74, s71, 2560
    s_mov_b32 s56, s32
    s_mov_b32 s57, s33
    s_mov_b32 s58, s34
    s_mov_b32 s60, s48
    s_mov_b32 s61, s49
    s_mov_b32 s62, s50
    s_branch L_pkg_2
L_pk2_1:
    s_sub_u32 s75, s71, 320
    s_mul_i32 s72, s75, 607
    s_lshr_b32 s72, s72, 16
    s_mul_i32 s73, s72, 108
    s_sub_u32 s73, s75, s73
    s_mul_i32 s74, s75, 2560
    s_mov_b32 s56, s36
    s_mov_b32 s57, s37
    s_mov_b32 s58, s38
    s_mov_b32 s60, s52
    s_mov_b32 s61, s53
    s_mov_b32 s62, s54
L_pkg_2:
    s_mov_b32 s59, 0x20000
    s_mov_b32 s63, 0x20000
    s_mul_i32 s73, s73, 20480
    s_mul_i32 s72, s72, 160
    s_add_u32 s72, s72, s73
    v_add_u32 v20, 0, v1
    v_mul_u32_u24 v21, 6554, v20
    v_lshrrev_b32 v21, 16, v21
    v_mul_u32_u24 v22, 10, v21
    v_sub_u32 v22, v20, v22
    v_mul_u32_u24 v23, 1280, v21
    v_lshl_add_u32 v23, v22, 4, v23
    v_lshrrev_b32 v24, 2, v21
    v_mul_u32_u24 v24, 640, v24
    v_and_b32 v21, 3, v21
    v_lshrrev_b32 v25, 2, v22
    v_lshlrev_b32 v25, 8, v25
    v_lshl_add_u32 v25, v21, 6, v25
    v_and_b32 v26, 3, v22
    v_lshl_add_u32 v25, v26, 4, v25
    v_lshlrev_b32 v26, 5, v21
    v_and_b32 v27, 1, v22
    v_lshl_add_u32 v26, v27, 4, v26
    v_add_u32 v26, 512, v26
    v_cmp_gt_u32 vcc, 8, v22
    s_nop 1
    v_cndmask_b32 v25, v26, v25, vcc
    v_add_u32 v24, v24, v25
    v_add_u32 v28, s70, v24
    buffer_load_dwordx4 v[32:35], v23, s[56:59], s72 offen
    v_add_u32 v20, 64, v1
    v_mul_u32_u24 v21, 6554, v20
    v_lshrrev_b32 v21, 16, v21
    v_mul_u32_u24 v22, 10, v21
    v_sub_u32 v22, v20, v22
    v_mul_u32_u24 v23, 1280, v21
    v_lshl_add_u32 v23, v22, 4, v23
    v_lshrrev_b32 v24, 2, v21
    v_mul_u32_u24 v24, 640, v24
    v_and_b32 v21, 3, v21
    v_lshrrev_b32 v25, 2, v22
    v_lshlrev_b32 v25, 8, v25
    v_lshl_add_u32 v25, v21, 6, v25
    v_and_b32 v26, 3, v22
    v_lshl_add_u32 v25, v26, 4, v25
    v_lshlrev_b32 v26, 5, v21
    v_and_b32 v27, 1, v22
    v_lshl_add_u32 v26, v27, 4, v26
    v_add_u32 v26, 512, v26
    v_cmp_gt_u32 vcc, 8, v22
    s_nop 1
    v_cndmask_b32 v25, v26, v25, vcc
    v_add_u32 v24, v24, v25
    v_add_u32 v29, s70, v24
    buffer_load_dwordx4 v[36:39], v23, s[56:59], s72 offen
    v_add_u32 v20, 128, v1
    v_mul_u32_u24 v21, 6554, v20
    v_lshrrev_b32 v21, 16, v21
    v_mul_u32_u24 v22, 10, v21
    v_sub_u32 v22, v20, v22
    v_mul_u32_u24 v23, 1280, v21
    v_lshl_add_u32 v23, v22, 4, v23
    v_lshrrev_b32 v24, 2, v21
    v_mul_u32_u24 v24, 640, v24
    v_and_b32 v21, 3, v21
    v_lshrrev_b32 v25, 2, v22
    v_lshlrev_b32 v25, 8, v25
    v_lshl_add_u32 v25, v21, 6, v25
    v_and_b32 v26, 3, v22
    v_lshl_add_u32 v25, v26, 4, v25
    v_lshlrev_b32 v26, 5, v21
    v_and_b32 v27, 1, v22
    v_lshl_add_u32 v26, v27, 4, v26
    v_add_u32 v26, 512, v26
    v_cmp_gt_u32 vcc, 8, v22
    s_nop 1
    v_cndmask_b32 v25, v26, v25, vcc
    v_add_u32 v24, v24, v25
    v_add_u32 v30, s70, v24
    v_cmp_gt_u32 vcc, 160, v20
    v_mov_b32 v21, s101
    s_nop 0
    v_cndmask_b32 v23, v21, v23, vcc
    buffer_load_dwordx4 v[40:43], v23, s[56:59], s72 offen
    v_mul_u32_u24 v20, 640, v2
    v_add_u32 v20, s70, v20
    v_and_b32 v21, 3, v1
    v_lshl_add_u32 v20, v21, 3, v20
    v_bfe_u32 v21, v1, 2, 2
    v_lshl_add_u32 v22, v21, 5, v20
    v_add_u32 v22, 512, v22
    v_lshl_add_u32 v20, v21, 6, v20
    v_bfe_u32 v21, v1, 4, 1
    v_lshl_add_u32 v20, v21, 5, v20
    v_lshlrev_b32 v24, 4, v1
    v_and_b32 v25, 15, v1
    v_lshlrev_b32 v25, 4, v25
    v_lshl_add_u32 v25, v2, 8, v25
    v_add_u32 v25, 2048, v25
    v_cmp_eq_u32 vcc, 0, v21
    v_mov_b32 v26, s101
    s_nop 0
    v_cndmask_b32 v25, v26, v25, vcc
    s_waitcnt vmcnt(3)
    v_mov_b32 v56, 0
    v_mov_b32 v57, 0
    v_lshlrev_b32 v58, 16, v8
    v_and_b32 v59, 0xffff0000, v8
    v_add_f32 v56, v56, v58
    v_fmac_f32 v57, v58, v58
    v_add_f32 v56, v56, v59
    v_fmac_f32 v57, v59, v59
    v_lshlrev_b32 v58, 16, v9
    v_and_b32 v59, 0xffff0000, v9
    v_add_f32 v56, v56, v58
    v_fmac_f32 v57, v58, v58
    v_add_f32 v56, v56, v59
    v_fmac_f32 v57, v59, v59
    v_lshlrev_b32 v58, 16, v10
    v_and_b32 v59, 0xffff0000, v10
    v_add_f32 v56, v56, v58
    v_fmac_f32 v57, v58, v58
    v_add_f32 v56, v56, v59
    v_fmac_f32 v57, v59, v59
    v_lshlrev_b32 v58, 16, v11
    v_and_b32 v59, 0xffff0000, v11
    v_add_f32 v56, v56, v58
    v_fmac_f32 v57, v58, v58
    v_add_f32 v56, v56, v59
    v_fmac_f32 v57, v59, v59
    v_lshlrev_b32 v58, 16, v12
    v_and_b32 v59, 0xffff0000, v12
    v_add_f32 v56, v56, v58
    v_fmac_f32 v57, v58, v58
    v_add_f32 v56, v56, v59
    v_fmac_f32 v57, v59, v59
    v_lshlrev_b32 v58, 16, v13
    v_and_b32 v59, 0xffff0000, v13
    v_add_f32 v56, v56, v58
    v_fmac_f32 v57, v58, v58
    v_add_f32 v56, v56, v59
    v_fmac_f32 v57, v59, v59
    v_lshlrev_b32 v58, 16, v14
    v_and_b32 v59, 0xffff0000, v14
    v_add_f32 v56, v56, v58
    v_fmac_f32 v57, v58, v58
    v_add_f32 v56, v56, v59
    v_fmac_f32 v57, v59, v59
    v_lshlrev_b32 v58, 16, v15
    v_and_b32 v59, 0xffff0000, v15
    v_add_f32 v56, v56, v58
    v_fmac_f32 v57, v58, v58
    v_add_f32 v56, v56, v59
    v_fmac_f32 v57, v59, v59
    v_lshlrev_b32 v58, 16, v16
    v_and_b32 v59, 0xffff0000, v16
    v_add_f32 v56, v56, v58
    v_fmac_f32 v57, v58, v58
    v_add_f32 v56, v56, v59
    v_fmac_f32 v57, v59, v59
    v_lshlrev_b32 v58, 16, v17
    v_and_b32 v59, 0xffff0000, v17
    v_add_f32 v56, v56, v58
    v_fmac_f32 v57, v58, v58
    v_add_f32 v56, v56, v59
    v_fmac_f32 v57, v59, v59
    v_lshlrev_b32 v58, 16, v18
    v_and_b32 v59, 0xffff0000, v18
    v_add_f32 v56, v56, v58
    v_fmac_f32 v57, v58, v58
    v_add_f32 v56, v56, v59
    v_fmac_f32 v57, v59, v59
    v_lshlrev_b32 v58, 16, v19
    v_and_b32 v59, 0xffff0000, v19
    v_add_f32 v56, v56, v58
    v_fmac_f32 v57, v58, v58
    v_add_f32 v56, v56, v59
    v_fmac_f32 v57, v59, v59
    v_permlane32_swap_b32 v8, v10
    v_permlane32_swap_b32 v9, v11
    v_permlane32_swap_b32 v12, v14
    v_permlane32_swap_b32 v13, v15
    v_permlane32_swap_b32 v16, v18
    v_permlane32_swap_b32 v17, v19
    s_mul_i32 s66, s64, 40
    s_mul_i32 s67, s65, 10
    s_add_u32 s66, s66, s67
    s_add_u32 s66, s66, s3
    s_lshl_b32 s66, s66, 10
    v_lshlrev_b32 v60, 4, v1
    v_add_u32 v60, s66, v60
    s_cmp_lt_u32 s3, 2
    s_cselect_b32 s82, 8192, s101
    s_mov_b32 s67, 4096
    buffer_store_dwordx4 v[8:11], v60, s[24:27], 0 offen sc1
    buffer_store_dwordx4 v[12:15], v60, s[24:27], s67 offen sc1
    buffer_store_dwordx4 v[16:19], v60, s[24:27], s82 offen sc1
    v_mov_b32 v58, v56
    s_nop 1
    v_permlane32_swap_b32 v56, v58
    v_add_f32 v56, v56, v58
    v_mov_b32 v59, v57
    s_nop 1
    v_permlane32_swap_b32 v57, v59
    v_add_f32 v57, v57, v59
    s_lshl_b32 s66, s64, 12
    s_lshl_b32 s67, s65, 2
    s_add_u32 s67, s67, s3
    s_lshr_b32 s68, s67, 1
    s_lshl_b32 s68, s68, 9
    s_add_u32 s66, s66, s68
    s_and_b32 s67, s67, 1
    s_lshl_b32 s67, s67, 3
    s_add_u32 s66, s66, s67
    v_lshlrev_b32 v60, 4, v3
    v_add_u32 v60, s66, v60
    buffer_store_dwordx2 v[56:57], v60, s[28:31], 0 offen sc1
    s_waitcnt vmcnt(4)
    ds_write_b128 v28, v[32:35]
    ds_write_b128 v29, v[36:39]
    s_mov_b32 exec_hi, 0
    ds_write_b128 v30, v[40:43]
    s_mov_b32 exec_hi, -1
    s_waitcnt lgkmcnt(0)
    ds_read_b64_tr_b16 v[32:33], v20
    ds_read_b64_tr_b16 v[34:35], v20 offset:1280
    ds_read_b64_tr_b16 v[36:37], v20 offset:256
    ds_read_b64_tr_b16 v[38:39], v20 offset:1536
    ds_read_b64_tr_b16 v[40:41], v22
    ds_read_b64_tr_b16 v[42:43], v22 offset:1280
    s_waitcnt lgkmcnt(0)
    buffer_store_dwordx4 v[32:35], v24, s[60:63], s74 offen sc1
    buffer_store_dwordx4 v[36:39], v24, s[60:63], s74 offen offset:1024 sc1
    buffer_store_dwordx4 v[40:43], v25, s[60:63], s74 offen sc1
    s_add_u32 s71, s71, 1024
    s_cmp_ge_u32 s71, 1184
    s_cbranch_scc1 L_pk_no2_3
    s_cmp_ge_u32 s71, 320
    s_cbranch_scc1 L_pk2_4
    s_mul_i32 s72, s71, 1639
    s_lshr_b32 s72, s72, 16
    s_mul_i32 s73, s72, 40
    s_sub_u32 s73, s71, s73
    s_mul_i32 s74, s71, 2560
    s_mov_b32 s56, s32
    s_mov_b32 s57, s33
    s_mov_b32 s58, s34
    s_mov_b32 s60, s48
    s_mov_b32 s61, s49
    s_mov_b32 s62, s50
    s_branch L_pkg_5
L_pk2_4:
    s_sub_u32 s75, s71, 320
    s_mul_i32 s72, s75, 607
    s_lshr_b32 s72, s72, 16
    s_mul_i32 s73, s72, 108
    s_sub_u32 s73, s75, s73
    s_mul_i32 s74, s75, 2560
    s_mov_b32 s56, s36
    s_mov_b32 s57, s37
    s_mov_b32 s58, s38
    s_mov_b32 s60, s52
    s_mov_b32 s61, s53
    s_mov_b32 s62, s54
L_pkg_5:
    s_mov_b32 s59, 0x20000
    s_mov_b32 s63, 0x20000
    s_mul_i32 s73, s73, 20480
    s_mul_i32 s72, s72, 160
    s_add_u32 s72, s72, s73
    v_add_u32 v20, 0, v1
    v_mul_u32_u24 v21, 6554, v20
    v_lshrrev_b32 v21, 16, v21
    v_mul_u32_u24 v22, 10, v21
    v_sub_u32 v22, v20, v22
    v_mul_u32_u24 v23, 1280, v21
    v_lshl_add_u32 v23, v22, 4, v23
    v_lshrrev_b32 v24, 2, v21
    v_mul_u32_u24 v24, 640, v24
    v_and_b32 v21, 3, v21
    v_lshrrev_b32 v25, 2, v22
    v_lshlrev_b32 v25, 8, v25
    v_lshl_add_u32 v25, v21, 6, v25
    v_and_b32 v26, 3, v22
    v_lshl_add_u32 v25, v26, 4, v25
    v_lshlrev_b32 v26, 5, v21
    v_and_b32 v27, 1, v22
    v_lshl_add_u32 v26, v27, 4, v26
    v_add_u32 v26, 512, v26
    v_cmp_gt_u32 vcc, 8, v22
    s_nop 1
    v_cndmask_b32 v25, v26, v25, vcc
    v_add_u32 v24, v24, v25
    v_add_u32 v28, s70, v24
    buffer_load_dwordx4 v[32:35], v23, s[56:59], s72 offen
    v_add_u32 v20, 64, v1
    v_mul_u32_u24 v21, 6554, v20
    v_lshrrev_b32 v21, 16, v21
    v_mul_u32_u24 v22, 10, v21
    v_sub_u32 v22, v20, v22
    v_mul_u32_u24 v23, 1280, v21
    v_lshl_add_u32 v23, v22, 4, v23
    v_lshrrev_b32 v24, 2, v21
    v_mul_u32_u24 v24, 640, v24
    v_and_b32 v21, 3, v21
    v_lshrrev_b32 v25, 2, v22
    v_lshlrev_b32 v25, 8, v25
    v_lshl_add_u32 v25, v21, 6, v25
    v_and_b32 v26, 3, v22
    v_lshl_add_u32 v25, v26, 4, v25
    v_lshlrev_b32 v26, 5, v21
    v_and_b32 v27, 1, v22
    v_lshl_add_u32 v26, v27, 4, v26
    v_add_u32 v26, 512, v26
    v_cmp_gt_u32 vcc, 8, v22
    s_nop 1
    v_cndmask_b32 v25, v26, v25, vcc
    v_add_u32 v24, v24, v25
    v_add_u32 v29, s70, v24
    buffer_load_dwordx4 v[36:39], v23, s[56:59], s72 offen
    v_add_u32 v20, 128, v1
    v_mul_u32_u24 v21, 6554, v20
    v_lshrrev_b32 v21, 16, v21
    v_mul_u32_u24 v22, 10, v21
    v_sub_u32 v22, v20, v22
    v_mul_u32_u24 v23, 1280, v21
    v_lshl_add_u32 v23, v22, 4, v23
    v_lshrrev_b32 v24, 2, v21
    v_mul_u32_u24 v24, 640, v24
    v_and_b32 v21, 3, v21
    v_lshrrev_b32 v25, 2, v22
    v_lshlrev_b32 v25, 8, v25
    v_lshl_add_u32 v25, v21, 6, v25
    v_and_b32 v26, 3, v22
    v_lshl_add_u32 v25, v26, 4, v25
    v_lshlrev_b32 v26, 5, v21
    v_and_b32 v27, 1, v22
    v_lshl_add_u32 v26, v27, 4, v26
    v_add_u32 v26, 512, v26
    v_cmp_gt_u32 vcc, 8, v22
    s_nop 1
    v_cndmask_b32 v25, v26, v25, vcc
    v_add_u32 v24, v24, v25
    v_add_u32 v30, s70, v24
    v_cmp_gt_u32 vcc, 160, v20
    v_mov_b32 v21, s101
    s_nop 0
    v_cndmask_b32 v23, v21, v23, vcc
    buffer_load_dwordx4 v[40:43], v23, s[56:59], s72 offen
    v_mul_u32_u24 v20, 640, v2
    v_add_u32 v20, s70, v20
    v_and_b32 v21, 3, v1
    v_lshl_add_u32 v20, v21, 3, v20
    v_bfe_u32 v21, v1, 2, 2
    v_lshl_add_u32 v22, v21, 5, v20
    v_add_u32 v22, 512, v22
    v_lshl_add_u32 v20, v21, 6, v20
    v_bfe_u32 v21, v1, 4, 1
    v_lshl_add_u32 v20, v21, 5, v20
    v_lshlrev_b32 v24, 4, v1
    v_and_b32 v25, 15, v1
    v_lshlrev_b32 v25, 4, v25
    v_lshl_add_u32 v25, v2, 8, v25
    v_add_u32 v25, 2048, v25
    v_cmp_eq_u32 vcc, 0, v21
    v_mov_b32 v26, s101
    s_nop 0
    v_cndmask_b32 v25, v26, v25, vcc
    s_waitcnt vmcnt(0)
    ds_write_b128 v28, v[32:35]
    ds_write_b128 v29, v[36:39]
    s_mov_b32 exec_hi, 0
    ds_write_b128 v30, v[40:43]
    s_mov_b32 exec_hi, -1
    s_waitcnt lgkmcnt(0)
    ds_read_b64_tr_b16 v[32:33], v20
    ds_read_b64_tr_b16 v[34:35], v20 offset:1280
    ds_read_b64_tr_b16 v[36:37], v20 offset:256
    ds_read_b64_tr_b16 v[38:39], v20 offset:1536
    ds_read_b64_tr_b16 v[40:41], v22
    ds_read_b64_tr_b16 v[42:43], v22 offset:1280
    s_waitcnt lgkmcnt(0)
    buffer_store_dwordx4 v[32:35], v24, s[60:63], s74 offen sc1
    buffer_store_dwordx4 v[36:39], v24, s[60:63], s74 offen offset:1024 sc1
    buffer_store_dwordx4 v[40:43], v25, s[60:63], s74 offen sc1
L_pk_no2_3:
    s_waitcnt vmcnt(0)
    s_barrier
    s_barrier
    s_barrier
    s_cmp_lg_u32 s3, 0
    s_cbranch_scc1 L_w0_6
    s_lshr_b32 s66, s2, 4
    v_lshlrev_b32 v12, 4, v1
    v_add_u32 v12, s66, v12
    s_and_b32 s66, s2, 15
    v_mov_b32 v13, s66
    s_lshr_b32 s66, s2, 3
    s_lshl_b32 s66, s66, 4
    s_sub_u32 s66, s66, 16
    v_add_u32 v14, s66, v1
    v_bfe_u32 v15, v1, 4, 2
    v_cmp_eq_u32 vcc, 1, v15
    s_and_b32 s66, s2, 7
    s_add_u32 s66, s66, 16
    v_mov_b32 v15, s66
    v_cndmask_b32 v12, v12, v14, vcc
    v_cndmask_b32 v13, v13, v15, vcc
    s_cmp_lt_u32 s2, 120
    s_cselect_b64 s[92:93], -1, 0
    s_and_b64 s[92:93], s[92:93], vcc
    v_cmp_gt_u32 vcc, 15, v1
    s_nop 1
    s_or_b64 vcc, vcc, s[92:93]
    s_mov_b32 s66, 0
    v_lshlrev_b32 v12, 9, v12
    v_lshl_add_u32 v252, v13, 4, v12
    v_add_u32 v252, s66, v252
    v_mov_b32 v12, s101
    v_cndmask_b32 v252, v12, v252, vcc
    s_mov_b32 s12, s10
    s_mov_b32 s13, s11
    s_mov_b32 s14, 256
    s_mov_b32 s15, 0x20000
    s_mov_b32 s95, 0x10000
    s_and_b32 s66, s2, 1
    s_lshl_b32 s66, s66, 7
    v_mov_b32 v244, s66
L_nonce_poll:
    buffer_load_dwordx2 v[248:249], v244, s[12:15], 0 offen sc0 sc1
    s_waitcnt vmcnt(0)
    v_readfirstlane_b32 s6, v248
    v_readfirstlane_b32 s66, v249
    s_nop 1
    s_cmp_eq_u32 s66, 1
    s_cbranch_scc1 L_w0_6
    s_sub_u32 s95, s95, 1
    s_cmp_lg_u32 s95, 0
    s_cbranch_scc1 L_nonce_poll
L_w0_6:
    s_barrier
    s_cmp_lg_u32 s3, 0
    s_cbranch_scc1 L_fl_7
    v_mov_b32 v248, s6
    buffer_store_dword v248, v252, s[96:99], 0 offen sc0 sc1
L_fl_7:
C_QKV:
    s_and_b32 s41, s2, 7
    s_lshr_b32 s42, s2, 3
    s_and_b32 s29, s41, 3
    s_lshl_b32 s29, s29, 2
    s_and_b32 s43, s42, 3
    s_add_u32 s29, s29, s43
    s_lshr_b32 s41, s41, 2
    s_lshr_b32 s42, s42, 2
    s_lshl_b32 s30, s41, 3
    s_add_u32 s30, s30, s42
    s_cmp_ge_u32 s30, 15
    s_cbranch_scc1 C_ATT
    s_cmp_ge_u32 s30, 5
    s_cselect_b32 s31, 1, 0
    s_cmp_ge_u32 s30, 10
    s_cselect_b32 s31, 2, s31
    s_mov_b32 s38, 3840
    s_mov_b32 s40, 7680
    s_lshl_b32 s39, s30, 7
    s_branch C_WIDE
C_FA:
    s_and_b32 s41, s2, 7
    s_lshr_b32 s42, s2, 3
    s_and_b32 s29, s41, 3
    s_lshl_b32 s29, s29, 2
    s_and_b32 s43, s42, 3
    s_add_u32 s29, s29, s43
    s_lshr_b32 s41, s41, 2
    s_lshr_b32 s42, s42, 2
    s_mul_i32 s30, s41, 7
    s_add_u32 s30, s30, s42
    s_cmp_ge_u32 s42, 7
    s_cbranch_scc1 C_FB
    s_mov_b32 s31, 3
    s_mov_b32 s38, 3456
    s_mov_b32 s40, 6912
    s_lshl_b32 s39, s30, 7
C_WIDE:
    s_cmp_lg_u32 s3, 0
    s_cbranch_scc1 L_w0_8
    s_cmp_eq_u32 s31, 3
    s_cbranch_scc1 L_swf_9
    s_mul_i32 s41, s30, 205
    s_lshr_b32 s41, s41, 10
    s_mul_i32 s42, s41, 5
    s_sub_u32 s42, s30, s42
    s_lshl_b32 s43, s42, 7
    s_mul_i32 s95, s43, 3277
    s_lshr_b32 s95, s95, 16
    s_add_u32 s43, s43, 127
    s_mul_i32 s43, s43, 3277
    s_lshr_b32 s43, s43, 16
    s_cmp_eq_u32 s41, 0
    s_cbranch_scc1 L_mbq_11
    v_lshrrev_b32 v14, 3, v1
    v_add_u32 v14, s95, v14
    v_and_b32 v12, 7, v1
    v_lshl_add_u32 v12, v12, 5, v14
    v_mul_u32_u24 v15, 20, v14
    v_lshrrev_b32 v15, 7, v15
    v_cmp_ne_u32 vcc, s42, v15
    s_sub_u32 s41, s41, 1
    s_lshl_b32 s41, s41, 5
    s_add_u32 s41, s41, s29
    v_mov_b32 v13, s41
    v_add_u32 v15, 16, v13
    v_cndmask_b32 v13, v13, v15, vcc
    v_cmp_ge_u32 vcc, s43, v14
    s_branch L_mbd_12
L_mbq_11:
    v_add_u32 v14, s95, v1
    s_lshr_b32 s41, s29, 1
    s_lshl_b32 s41, s41, 5
    v_add_u32 v12, s41, v14
    v_mul_u32_u24 v15, 20, v14
    v_lshrrev_b32 v15, 7, v15
    v_cmp_ne_u32 vcc, s42, v15
    s_and_b32 s41, s29, 1
    s_add_u32 s41, s41, 64
    v_mov_b32 v13, s41
    v_add_u32 v15, 2, v13
    v_cndmask_b32 v13, v13, v15, vcc
    v_cmp_ge_u32 vcc, s43, v14
    v_cmp_gt_u32 s[92:93], 8, v1
    s_nop 1
    s_and_b64 vcc, vcc, s[92:93]
L_mbd_12:
    s_mov_b32 s41, s7
    s_mul_i32 s41, s41, 0x100000
    s_add_u32 s41, s41, 0x80000
    v_lshlrev_b32 v12, 11, v12
    v_lshl_add_u32 v252, v13, 4, v12
    v_add_u32 v252, s41, v252
    v_mov_b32 v12, s101
    v_cndmask_b32 v252, v12, v252, vcc
    s_branch L_swd_10
L_swf_9:
    s_lshl_b32 s41, s29, 4
    v_mov_b32 v12, v1
    v_add_u32 v12, s41, v12
    v_mov_b32 v13, s30
    v_cmp_gt_u32 vcc, 16, v1
    s_mov_b32 s42, s7
    s_mul_i32 s42, s42, 0x100000
    s_add_u32 s42, s42, 0x60000
    v_lshlrev_b32 v12, 9, v12
    v_lshl_add_u32 v252, v13, 4, v12
    v_add_u32 v252, s42, v252
    v_mov_b32 v12, s101
    v_cndmask_b32 v252, v12, v252, vcc
L_swd_10:
    s_lshl_b32 s41, s30, 4
    s_add_u32 s41, s41, s29
    s_lshl_b32 s42, s29, 4
    s_add_u32 s42, s42, s30
    s_cmp_eq_u32 s31, 3
    s_cselect_b32 s41, s42, s41
    s_cselect_b32 s43, 0x40000, 0
    s_lshl_b32 s41, s41, 9
    s_add_u32 s41, s41, s43
    s_mul_i32 s94, s7, 0x100000
    s_add_u32 s94, s94, s41
    s_cmp_eq_u32 s31, 3
    s_cselect_b32 s42, 1, s7
    s_cmp_eq_u32 s42, 0
    s_cselect_b32 s42, 24, 16
    v_lshlrev_b32 v244, 4, v1
    v_cmp_gt_u32 vcc, s42, v1
    v_mov_b32 v12, s101
    v_mov_b32 v245, s6
    v_cndmask_b32 v244, v12, v244, vcc
    v_cndmask_b32 v245, 0, v245, vcc
L_w0_8:
    s_and_b32 s44, s3, 1
    s_lshr_b32 s45, s3, 1
    s_mov_b32 s41, 0x1000000
    s_mov_b32 s42, 2621440
    s_cmp_eq_u32 s31, 1
    s_cselect_b32 s41, 0x1280000, s41
    s_cmp_eq_u32 s31, 2
    s_cselect_b32 s41, 0x1500000, s41
    s_cselect_b32 s42, 2883584, s42
    s_cmp_eq_u32 s31, 3
    s_cselect_b32 s41, 0x1a80000, s41
    s_cselect_b32 s42, 7077888, s42
    s_mul_i32 s43, s7, 0x1400000
    s_add_u32 s41, s41, s43
    s_add_u32 s24, s4, s41
    s_addc_u32 s25, s5, 0
    s_mov_b32 s26, s42
    s_mov_b32 s27, 0x20000
    v_lshlrev_b32 v4, 4, v1
    s_lshl_b32 s41, s45, 13
    s_add_u32 s41, s41, 98304
    v_add_u32 v9, s41, v4
    s_mov_b32 s54, 0
    s_mov_b32 s55, 0
    s_mov_b32 s63, 16384
    v_lshlrev_b32 v10, 10, v2
    v_bfe_u32 v11, v1, 2, 2
    v_lshlrev_b32 v11, 6, v11
    v_add_u32 v10, v10, v11
    v_bfe_u32 v11, v1, 4, 1
    v_lshlrev_b32 v11, 5, v11
    v_add_u32 v10, v10, v11
    v_and_b32 v11, 3, v1
    v_lshlrev_b32 v11, 3, v11
    v_add_u32 v10, v10, v11
    s_lshl_b32 s41, s44, 9
    v_add_u32 v10, s41, v10
    v_add_u32 v5, 0x10000, v10
    v_mov_b32 v192, 0
    v_mov_b32 v193, 0
    v_mov_b32 v194, 0
    v_mov_b32 v195, 0
    v_mov_b32 v228, 0
    v_mov_b32 v229, 0
    s_cmp_eq_u32 s31, 3
    s_cbranch_scc1 L_cw_addr_done
    s_cmp_eq_u32 s31, 2
    s_cbranch_scc1 L_cw_addr_v
    s_mul_i32 s41, s31, 640
    s_sub_u32 s41, s39, s41
    s_lshl_b32 s42, s44, 6
    s_add_u32 s41, s41, s42
    s_lshr_b32 s41, s41, 3
    v_add_u32 v11, s41, v2
    v_lshlrev_b32 v16, 4, v3
    v_add_u32 v12, 0, v11
    v_mul_u32_u24 v13, 205, v12
    v_lshrrev_b32 v13, 10, v13
    v_mul_u32_u24 v14, 5, v13
    v_sub_u32 v14, v12, v14
    v_mul_u32_u24 v192, 163840, v13
    v_lshl_add_u32 v192, v14, 9, v192
    v_add_u32 v192, v192, v16
    v_add_u32 v12, 2, v11
    v_mul_u32_u24 v13, 205, v12
    v_lshrrev_b32 v13, 10, v13
    v_mul_u32_u24 v14, 5, v13
    v_sub_u32 v14, v12, v14
    v_mul_u32_u24 v193, 163840, v13
    v_lshl_add_u32 v193, v14, 9, v193
    v_add_u32 v193, v193, v16
    v_add_u32 v12, 4, v11
    v_mul_u32_u24 v13, 205, v12
    v_lshrrev_b32 v13, 10, v13
    v_mul_u32_u24 v14, 5, v13
    v_sub_u32 v14, v12, v14
    v_mul_u32_u24 v194, 163840, v13
    v_lshl_add_u32 v194, v14, 9, v194
    v_add_u32 v194, v194, v16
    v_add_u32 v12, 6, v11
    v_mul_u32_u24 v13, 205, v12
    v_lshrrev_b32 v13, 10, v13
    v_mul_u32_u24 v14, 5, v13
    v_sub_u32 v14, v12, v14
    v_mul_u32_u24 v195, 163840, v13
    v_lshl_add_u32 v195, v14, 9, v195
    v_add_u32 v195, v195, v16
    s_branch L_cw_addr_done
L_cw_addr_v:
    s_lshl_b32 s41, s44, 6
    v_add_u32 v11, s41, v3
    s_sub_u32 s41, s39, 1280
    v_add_u32 v11, s41, v11
    s_movk_i32 s42, 3277
    v_add_u32 v12, 0, v11
    v_mul_u32_u24 v13, s42, v12
    v_lshrrev_b32 v13, 16, v13
    v_mul_u32_u24 v14, 20, v13
    v_sub_u32 v14, v12, v14
    v_mul_u32_u24 v228, 90112, v13
    v_mul_u32_u24 v15, 22, v2
    v_add_u32 v15, v15, v14
    v_lshl_add_u32 v228, v15, 4, v228
    v_add_u32 v12, 32, v11
    v_mul_u32_u24 v13, s42, v12
    v_lshrrev_b32 v13, 16, v13
    v_mul_u32_u24 v14, 20, v13
    v_sub_u32 v14, v12, v14
    v_mul_u32_u24 v229, 90112, v13
    v_mul_u32_u24 v15, 22, v2
    v_add_u32 v15, v15, v14
    v_lshl_add_u32 v229, v15, 4, v229
L_cw_addr_done:
    v_mov_b32 v96, 0
    v_mov_b32 v97, 0
    v_mov_b32 v98, 0
    v_mov_b32 v99, 0
    v_mov_b32 v100, 0
    v_mov_b32 v101, 0
    v_mov_b32 v102, 0
    v_mov_b32 v103, 0
    v_mov_b32 v104, 0
    v_mov_b32 v105, 0
    v_mov_b32 v106, 0
    v_mov_b32 v107, 0
    v_mov_b32 v108, 0
    v_mov_b32 v109, 0
    v_mov_b32 v110, 0
    v_mov_b32 v111, 0
    v_mov_b32 v112, 0
    v_mov_b32 v113, 0
    v_mov_b32 v114, 0
    v_mov_b32 v115, 0
    v_mov_b32 v116, 0
    v_mov_b32 v117, 0
    v_mov_b32 v118, 0
    v_mov_b32 v119, 0
    v_mov_b32 v120, 0
    v_mov_b32 v121, 0
    v_mov_b32 v122, 0
    v_mov_b32 v123, 0
    v_mov_b32 v124, 0
    v_mov_b32 v125, 0
    v_mov_b32 v126, 0
    v_mov_b32 v127, 0
    v_mov_b32 v128, 0
    v_mov_b32 v129, 0
    v_mov_b32 v130, 0
    v_mov_b32 v131, 0
    v_mov_b32 v132, 0
    v_mov_b32 v133, 0
    v_mov_b32 v134, 0
    v_mov_b32 v135, 0
    v_mov_b32 v136, 0
    v_mov_b32 v137, 0
    v_mov_b32 v138, 0
    v_mov_b32 v139, 0
    v_mov_b32 v140, 0
    v_mov_b32 v141, 0
    v_mov_b32 v142, 0
    v_mov_b32 v143, 0
    v_mov_b32 v144, 0
    v_mov_b32 v145, 0
    v_mov_b32 v146, 0
    v_mov_b32 v147, 0
    v_mov_b32 v148, 0
    v_mov_b32 v149, 0
    v_mov_b32 v150, 0
    v_mov_b32 v151, 0
    v_mov_b32 v152, 0
    v_mov_b32 v153, 0
    v_mov_b32 v154, 0
    v_mov_b32 v155, 0
    v_mov_b32 v156, 0
    v_mov_b32 v157, 0
    v_mov_b32 v158, 0
    v_mov_b32 v159, 0
    s_cmp_lg_u32 s3, 0
    s_cbranch_scc1 L_polld_14
    s_mov_b32 s95, 0x10000
    buffer_load_dword v248, v244, s[96:99], s94 offen sc0 sc1
L_poll_13:
    s_waitcnt vmcnt(0)
    v_cmp_eq_u32 vcc, v248, v245
    s_nop 1
    s_cmp_eq_u64 vcc, exec
    s_cbranch_scc1 L_polld_14
    buffer_load_dword v248, v244, s[96:99], s94 offen sc0 sc1
    s_sub_u32 s95, s95, 1
    s_cmp_lg_u32 s95, 0
    s_cbranch_scc1 L_poll_13
L_polld_14:
    s_barrier
    s_cmp_eq_u32 s31, 0
    s_cselect_b32 s56, 0x3ea52b5c, 1.0
    s_cmp_eq_u32 s31, 3
    s_cselect_b64 s[58:59], -1, 0
    s_lshl_b32 s43, s45, 8
    s_add_u32 s43, s43, 147968
    v_lshlrev_b32 v17, 2, v3
    v_add_u32 v17, s43, v17
    s_barrier
    ds_read_b64_tr_b16 v[32:33], v10 offset:0
    ds_read_b64_tr_b16 v[34:35], v10 offset:2048
    ds_read_b128 v[40:43], v9 offset:0
    ds_read_b64_tr_b16 v[36:37], v10 offset:256
    ds_read_b64_tr_b16 v[38:39], v10 offset:2304
    ds_read_b128 v[44:47], v9 offset:4096
    ds_read_b64_tr_b16 v[48:49], v10 offset:4096
    ds_read_b64_tr_b16 v[50:51], v10 offset:6144
    ds_read_b128 v[56:59], v9 offset:1024
    ds_read_b64_tr_b16 v[52:53], v10 offset:4352
    ds_read_b64_tr_b16 v[54:55], v10 offset:6400
    ds_read_b128 v[60:63], v9 offset:5120
    s_cmp_eq_u32 s31, 2
    s_cbranch_scc1 L_cw_vmode
.p2align 6
    s_waitcnt lgkmcnt(6)
    v_mfma_f32_32x32x16_bf16 v[96:111], v[32:35], v[40:43], v[96:111]
    ds_read_b64_tr_b16 v[64:65], v10 offset:8192
    ds_read_b64_tr_b16 v[66:67], v10 offset:10240
    v_mfma_f32_32x32x16_bf16 v[112:127], v[32:35], v[44:47], v[112:127]
    ds_read_b128 v[72:75], v9 offset:2048
    ds_read_b64_tr_b16 v[68:69], v10 offset:8448
    v_mfma_f32_32x32x16_bf16 v[128:143], v[36:39], v[40:43], v[128:143]
    ds_read_b64_tr_b16 v[70:71], v10 offset:10496
    ds_read_b128 v[76:79], v9 offset:6144
    v_mfma_f32_32x32x16_bf16 v[144:159], v[36:39], v[44:47], v[144:159]
    s_waitcnt lgkmcnt(6)
    v_mfma_f32_32x32x16_bf16 v[96:111], v[48:51], v[56:59], v[96:111]
    ds_read_b64_tr_b16 v[80:81], v10 offset:12288
    ds_read_b64_tr_b16 v[82:83], v10 offset:14336
    v_mfma_f32_32x32x16_bf16 v[112:127], v[48:51], v[60:63], v[112:127]
    ds_read_b128 v[88:91], v9 offset:3072
    ds_read_b64_tr_b16 v[84:85], v10 offset:12544
    v_mfma_f32_32x32x16_bf16 v[128:143], v[52:55], v[56:59], v[128:143]
    ds_read_b64_tr_b16 v[86:87], v10 offset:14592
    ds_read_b128 v[92:95], v9 offset:7168
    v_mfma_f32_32x32x16_bf16 v[144:159], v[52:55], v[60:63], v[144:159]
    s_waitcnt lgkmcnt(0)
    v_mfma_f32_32x32x16_bf16 v[96:111], v[64:67], v[72:75], v[96:111]
    v_mfma_f32_32x32x16_bf16 v[112:127], v[64:67], v[76:79], v[112:127]
    s_barrier
    ds_read_b64_tr_b16 v[32:33], v10 offset:16384
    ds_read_b64_tr_b16 v[34:35], v10 offset:18432
    ds_read_b128 v[40:43], v9 offset:16384
    v_mfma_f32_32x32x16_bf16 v[128:143], v[68:71], v[72:75], v[128:143]
    ds_read_b64_tr_b16 v[36:37], v10 offset:16640
    ds_read_b64_tr_b16 v[38:39], v10 offset:18688
    ds_read_b128 v[44:47], v9 offset:20480
    v_mfma_f32_32x32x16_bf16 v[144:159], v[68:71], v[76:79], v[144:159]
    v_mfma_f32_32x32x16_bf16 v[96:111], v[80:83], v[88:91], v[96:111]
    ds_read_b64_tr_b16 v[48:49], v10 offset:20480
    ds_read_b64_tr_b16 v[50:51], v10 offset:22528
    v_mfma_f32_32x32x16_bf16 v[112:127], v[80:83], v[92:95], v[112:127]
    ds_read_b128 v[56:59], v9 offset:17408
    ds_read_b64_tr_b16 v[52:53], v10 offset:20736
    v_mfma_f32_32x32x16_bf16 v[128:143], v[84:87], v[88:91], v[128:143]
    ds_read_b64_tr_b16 v[54:55], v10 offset:22784
    ds_read_b128 v[60:63], v9 offset:21504
    v_mfma_f32_32x32x16_bf16 v[144:159], v[84:87], v[92:95], v[144:159]
    s_waitcnt lgkmcnt(6)
    v_mfma_f32_32x32x16_bf16 v[96:111], v[32:35], v[40:43], v[96:111]
    ds_read_b64_tr_b16 v[64:65], v10 offset:24576
    ds_read_b64_tr_b16 v[66:67], v10 offset:26624
    v_mfma_f32_32x32x16_bf16 v[112:127], v[32:35], v[44:47], v[112:127]
    ds_read_b128 v[72:75], v9 offset:18432
    ds_read_b64_tr_b16 v[68:69], v10 offset:24832
    v_mfma_f32_32x32x16_bf16 v[128:143], v[36:39], v[40:43], v[128:143]
    ds_read_b64_tr_b16 v[70:71], v10 offset:26880
    ds_read_b128 v[76:79], v9 offset:22528
    v_mfma_f32_32x32x16_bf16 v[144:159], v[36:39], v[44:47], v[144:159]
    s_waitcnt lgkmcnt(6)
    v_mfma_f32_32x32x16_bf16 v[96:111], v[48:51], v[56:59], v[96:111]
    ds_read_b64_tr_b16 v[80:81], v10 offset:28672
    ds_read_b64_tr_b16 v[82:83], v10 offset:30720
    v_mfma_f32_32x32x16_bf16 v[112:127], v[48:51], v[60:63], v[112:127]
    ds_read_b128 v[88:91], v9 offset:19456
    ds_read_b64_tr_b16 v[84:85], v10 offset:28928
    v_mfma_f32_32x32x16_bf16 v[128:143], v[52:55], v[56:59], v[128:143]
    ds_read_b64_tr_b16 v[86:87], v10 offset:30976
    ds_read_b128 v[92:95], v9 offset:23552
    v_mfma_f32_32x32x16_bf16 v[144:159], v[52:55], v[60:63], v[144:159]
    s_waitcnt lgkmcnt(0)
    v_mfma_f32_32x32x16_bf16 v[96:111], v[64:67], v[72:75], v[96:111]
    v_mfma_f32_32x32x16_bf16 v[112:127], v[64:67], v[76:79], v[112:127]
    s_barrier
    ds_read_b64_tr_b16 v[32:33], v10 offset:32768
    ds_read_b64_tr_b16 v[34:35], v10 offset:34816
    ds_read_b128 v[40:43], v9 offset:32768
    v_mfma_f32_32x32x16_bf16 v[128:143], v[68:71], v[72:75], v[128:143]
    ds_read_b64_tr_b16 v[36:37], v10 offset:33024
    ds_read_b64_tr_b16 v[38:39], v10 offset:35072
    ds_read_b128 v[44:47], v9 offset:36864
    v_mfma_f32_32x32x16_bf16 v[144:159], v[68:71], v[76:79], v[144:159]
    v_mfma_f32_32x32x16_bf16 v[96:111], v[80:83], v[88:91], v[96:111]
    ds_read_b64_tr_b16 v[48:49], v10 offset:36864
    ds_read_b64_tr_b16 v[50:51], v10 offset:38912
    v_mfma_f32_32x32x16_bf16 v[112:127], v[80:83], v[92:95], v[112:127]
    ds_read_b128 v[56:59], v9 offset:33792
    ds_read_b64_tr_b16 v[52:53], v10 offset:37120
    v_mfma_f32_32x32x16_bf16 v[128:143], v[84:87], v[88:91], v[128:143]
    ds_read_b64_tr_b16 v[54:55], v10 offset:39168
    ds_read_b128 v[60:63], v9 offset:37888
    v_mfma_f32_32x32x16_bf16 v[144:159], v[84:87], v[92:95], v[144:159]
    s_waitcnt lgkmcnt(6)
    v_mfma_f32_32x32x16_bf16 v[96:111], v[32:35], v[40:43], v[96:111]
    ds_read_b64_tr_b16 v[64:65], v10 offset:40960
    ds_read_b64_tr_b16 v[66:67], v10 offset:43008
    v_mfma_f32_32x32x16_bf16 v[112:127], v[32:35], v[44:47], v[112:127]
    ds_read_b128 v[72:75], v9 offset:34816
    ds_read_b64_tr_b16 v[68:69], v10 offset:41216
    v_mfma_f32_32x32x16_bf16 v[128:143], v[36:39], v[40:43], v[128:143]
    ds_read_b64_tr_b16 v[70:71], v10 offset:43264
    ds_read_b128 v[76:79], v9 offset:38912
    v_mfma_f32_32x32x16_bf16 v[144:159], v[36:39], v[44:47], v[144:159]
    s_waitcnt lgkmcnt(6)
    v_mfma_f32_32x32x16_bf16 v[96:111], v[48:51], v[56:59], v[96:111]
    ds_read_b64_tr_b16 v[80:81], v10 offset:45056
    ds_read_b64_tr_b16 v[82:83], v10 offset:47104
    v_mfma_f32_32x32x16_bf16 v[112:127], v[48:51], v[60:63], v[112:127]
    ds_read_b128 v[88:91], v9 offset:35840
    ds_read_b64_tr_b16 v[84:85], v10 offset:45312
    v_mfma_f32_32x32x16_bf16 v[128:143], v[52:55], v[56:59], v[128:143]
    ds_read_b64_tr_b16 v[86:87], v10 offset:47360
    ds_read_b128 v[92:95], v9 offset:39936
    v_mfma_f32_32x32x16_bf16 v[144:159], v[52:55], v[60:63], v[144:159]
    s_waitcnt lgkmcnt(0)
    v_mfma_f32_32x32x16_bf16 v[96:111], v[64:67], v[72:75], v[96:111]
    v_mfma_f32_32x32x16_bf16 v[112:127], v[64:67], v[76:79], v[112:127]
    s_barrier
    ds_read_b64_tr_b16 v[32:33], v10 offset:49152
    ds_read_b64_tr_b16 v[34:35], v10 offset:51200
    ds_read_b128 v[40:43], v9 offset:0
    v_mfma_f32_32x32x16_bf16 v[128:143], v[68:71], v[72:75], v[128:143]
    ds_read_b64_tr_b16 v[36:37], v10 offset:49408
    ds_read_b64_tr_b16 v[38:39], v10 offset:51456
    ds_read_b128 v[44:47], v9 offset:4096
    v_mfma_f32_32x32x16_bf16 v[144:159], v[68:71], v[76:79], v[144:159]
    v_mfma_f32_32x32x16_bf16 v[96:111], v[80:83], v[88:91], v[96:111]
    ds_read_b64_tr_b16 v[48:49], v10 offset:53248
    ds_read_b64_tr_b16 v[50:51], v10 offset:55296
    v_mfma_f32_32x32x16_bf16 v[112:127], v[80:83], v[92:95], v[112:127]
    ds_read_b128 v[56:59], v9 offset:1024
    ds_read_b64_tr_b16 v[52:53], v10 offset:53504
    v_mfma_f32_32x32x16_bf16 v[128:143], v[84:87], v[88:91], v[128:143]
    ds_read_b64_tr_b16 v[54:55], v10 offset:55552
    ds_read_b128 v[60:63], v9 offset:5120
    v_mfma_f32_32x32x16_bf16 v[144:159], v[84:87], v[92:95], v[144:159]
    s_waitcnt lgkmcnt(6)
    v_mfma_f32_32x32x16_bf16 v[96:111], v[32:35], v[40:43], v[96:111]
    ds_read_b64_tr_b16 v[64:65], v10 offset:57344
    ds_read_b64_tr_b16 v[66:67], v10 offset:59392
    v_mfma_f32_32x32x16_bf16 v[112:127], v[32:35], v[44:47], v[112:127]
    ds_read_b128 v[72:75], v9 offset:2048
    ds_read_b64_tr_b16 v[68:69], v10 offset:57600
    v_mfma_f32_32x32x16_bf16 v[128:143], v[36:39], v[40:43], v[128:143]
    ds_read_b64_tr_b16 v[70:71], v10 offset:59648
    ds_read_b128 v[76:79], v9 offset:6144
    v_mfma_f32_32x32x16_bf16 v[144:159], v[36:39], v[44:47], v[144:159]
    s_waitcnt lgkmcnt(6)
    v_mfma_f32_32x32x16_bf16 v[96:111], v[48:51], v[56:59], v[96:111]
    ds_read_b64_tr_b16 v[80:81], v10 offset:61440
    ds_read_b64_tr_b16 v[82:83], v10 offset:63488
    v_mfma_f32_32x32x16_bf16 v[112:127], v[48:51], v[60:63], v[112:127]
    ds_read_b128 v[88:91], v9 offset:3072
    ds_read_b64_tr_b16 v[84:85], v10 offset:61696
    v_mfma_f32_32x32x16_bf16 v[128:143], v[52:55], v[56:59], v[128:143]
    ds_read_b64_tr_b16 v[86:87], v10 offset:63744
    ds_read_b128 v[92:95], v9 offset:7168
    v_mfma_f32_32x32x16_bf16 v[144:159], v[52:55], v[60:63], v[144:159]
    s_waitcnt lgkmcnt(0)
    v_mfma_f32_32x32x16_bf16 v[96:111], v[64:67], v[72:75], v[96:111]
    v_mfma_f32_32x32x16_bf16 v[112:127], v[64:67], v[76:79], v[112:127]
    s_barrier
    ds_read_b64_tr_b16 v[32:33], v5 offset:0
    ds_read_b64_tr_b16 v[34:35], v5 offset:2048
    ds_read_b128 v[40:43], v9 offset:16384
    v_mfma_f32_32x32x16_bf16 v[128:143], v[68:71], v[72:75], v[128:143]
    ds_read_b64_tr_b16 v[36:37], v5 offset:256
    ds_read_b64_tr_b16 v[38:39], v5 offset:2304
    ds_read_b128 v[44:47], v9 offset:20480
    v_mfma_f32_32x32x16_bf16 v[144:159], v[68:71], v[76:79], v[144:159]
    v_mfma_f32_32x32x16_bf16 v[96:111], v[80:83], v[88:91], v[96:111]
    ds_read_b64_tr_b16 v[48:49], v5 offset:4096
    ds_read_b64_tr_b16 v[50:51], v5 offset:6144
    v_mfma_f32_32x32x16_bf16 v[112:127], v[80:83], v[92:95], v[112:127]
    ds_read_b128 v[56:59], v9 offset:17408
    ds_read_b64_tr_b16 v[52:53], v5 offset:4352
    v_mfma_f32_32x32x16_bf16 v[128:143], v[84:87], v[88:91], v[128:143]
    ds_read_b64_tr_b16 v[54:55], v5 offset:6400
    ds_read_b128 v[60:63], v9 offset:21504
    v_mfma_f32_32x32x16_bf16 v[144:159], v[84:87], v[92:95], v[144:159]
    s_waitcnt lgkmcnt(6)
    v_mfma_f32_32x32x16_bf16 v[96:111], v[32:35], v[40:43], v[96:111]
    ds_read_b64_tr_b16 v[64:65], v5 offset:8192
    ds_read_b64_tr_b16 v[66:67], v5 offset:10240
    v_mfma_f32_32x32x16_bf16 v[112:127], v[32:35], v[44:47], v[112:127]
    ds_read_b128 v[72:75], v9 offset:18432
    ds_read_b64_tr_b16 v[68:69], v5 offset:8448
    v_mfma_f32_32x32x16_bf16 v[128:143], v[36:39], v[40:43], v[128:143]
    ds_read_b64_tr_b16 v[70:71], v5 offset:10496
    ds_read_b128 v[76:79], v9 offset:22528
    v_mfma_f32_32x32x16_bf16 v[144:159], v[36:39], v[44:47], v[144:159]
    s_waitcnt lgkmcnt(6)
    v_mfma_f32_32x32x16_bf16 v[96:111], v[48:51], v[56:59], v[96:111]
    ds_read_b64_tr_b16 v[80:81], v5 offset:12288
    ds_read_b64_tr_b16 v[82:83], v5 offset:14336
    v_mfma_f32_32x32x16_bf16 v[112:127], v[48:51], v[60:63], v[112:127]
    ds_read_b128 v[88:91], v9 offset:19456
    ds_read_b64_tr_b16 v[84:85], v5 offset:12544
    v_mfma_f32_32x32x16_bf16 v[128:143], v[52:55], v[56:59], v[128:143]
    ds_read_b64_tr_b16 v[86:87], v5 offset:14592
    ds_read_b128 v[92:95], v9 offset:23552
    v_mfma_f32_32x32x16_bf16 v[144:159], v[52:55], v[60:63], v[144:159]
    s_waitcnt lgkmcnt(0)
    v_mfma_f32_32x32x16_bf16 v[96:111], v[64:67], v[72:75], v[96:111]
    v_mfma_f32_32x32x16_bf16 v[112:127], v[64:67], v[76:79], v[112:127]
    s_barrier
    ds_read_b64_tr_b16 v[32:33], v5 offset:16384
    ds_read_b64_tr_b16 v[34:35], v5 offset:18432
    ds_read_b128 v[40:43], v9 offset:32768
    v_mfma_f32_32x32x16_bf16 v[128:143], v[68:71], v[72:75], v[128:143]
    ds_read_b64_tr_b16 v[36:37], v5 offset:16640
    ds_read_b64_tr_b16 v[38:39], v5 offset:18688
    ds_read_b128 v[44:47], v9 offset:36864
    v_mfma_f32_32x32x16_bf16 v[144:159], v[68:71], v[76:79], v[144:159]
    v_mfma_f32_32x32x16_bf16 v[96:111], v[80:83], v[88:91], v[96:111]
    ds_read_b64_tr_b16 v[48:49], v5 offset:20480
    ds_read_b64_tr_b16 v[50:51], v5 offset:22528
    v_mfma_f32_32x32x16_bf16 v[112:127], v[80:83], v[92:95], v[112:127]
    ds_read_b128 v[56:59], v9 offset:33792
    ds_read_b64_tr_b16 v[52:53], v5 offset:20736
    v_mfma_f32_32x32x16_bf16 v[128:143], v[84:87], v[88:91], v[128:143]
    ds_read_b64_tr_b16 v[54:55], v5 offset:22784
    ds_read_b128 v[60:63], v9 offset:37888
    v_mfma_f32_32x32x16_bf16 v[144:159], v[84:87], v[92:95], v[144:159]
    s_waitcnt lgkmcnt(6)
    v_mfma_f32_32x32x16_bf16 v[96:111], v[32:35], v[40:43], v[96:111]
    ds_read_b64_tr_b16 v[64:65], v5 offset:24576
    ds_read_b64_tr_b16 v[66:67], v5 offset:26624
    v_mfma_f32_32x32x16_bf16 v[112:127], v[32:35], v[44:47], v[112:127]
    ds_read_b128 v[72:75], v9 offset:34816
    ds_read_b64_tr_b16 v[68:69], v5 offset:24832
    v_mfma_f32_32x32x16_bf16 v[128:143], v[36:39], v[40:43], v[128:143]
    ds_read_b64_tr_b16 v[70:71], v5 offset:26880
    ds_read_b128 v[76:79], v9 offset:38912
    v_mfma_f32_32x32x16_bf16 v[144:159], v[36:39], v[44:47], v[144:159]
    s_waitcnt lgkmcnt(6)
    v_mfma_f32_32x32x16_bf16 v[96:111], v[48:51], v[56:59], v[96:111]
    ds_read_b64_tr_b16 v[80:81], v5 offset:28672
    ds_read_b64_tr_b16 v[82:83], v5 offset:30720
    v_mfma_f32_32x32x16_bf16 v[112:127], v[48:51], v[60:63], v[112:127]
    ds_read_b128 v[88:91], v9 offset:35840
    ds_read_b64_tr_b16 v[84:85], v5 offset:28928
    v_mfma_f32_32x32x16_bf16 v[128:143], v[52:55], v[56:59], v[128:143]
    ds_read_b64_tr_b16 v[86:87], v5 offset:30976
    ds_read_b128 v[92:95], v9 offset:39936
    v_mfma_f32_32x32x16_bf16 v[144:159], v[52:55], v[60:63], v[144:159]
    s_waitcnt lgkmcnt(0)
    v_mfma_f32_32x32x16_bf16 v[96:111], v[64:67], v[72:75], v[96:111]
    v_mfma_f32_32x32x16_bf16 v[112:127], v[64:67], v[76:79], v[112:127]
    s_barrier
    ds_read_b64_tr_b16 v[32:33], v10 offset:0
    ds_read_b64_tr_b16 v[34:35], v10 offset:2048
    ds_read_b128 v[40:43], v9 offset:0
    v_mfma_f32_32x32x16_bf16 v[128:143], v[68:71], v[72:75], v[128:143]
    ds_read_b64_tr_b16 v[36:37], v10 offset:256
    ds_read_b64_tr_b16 v[38:39], v10 offset:2304
    ds_read_b128 v[44:47], v9 offset:4096
    v_mfma_f32_32x32x16_bf16 v[144:159], v[68:71], v[76:79], v[144:159]
    v_mfma_f32_32x32x16_bf16 v[96:111], v[80:83], v[88:91], v[96:111]
    ds_read_b64_tr_b16 v[48:49], v10 offset:4096
    ds_read_b64_tr_b16 v[50:51], v10 offset:6144
    v_mfma_f32_32x32x16_bf16 v[112:127], v[80:83], v[92:95], v[112:127]
    ds_read_b128 v[56:59], v9 offset:1024
    ds_read_b64_tr_b16 v[52:53], v10 offset:4352
    v_mfma_f32_32x32x16_bf16 v[128:143], v[84:87], v[88:91], v[128:143]
    ds_read_b64_tr_b16 v[54:55], v10 offset:6400
    ds_read_b128 v[60:63], v9 offset:5120
    v_mfma_f32_32x32x16_bf16 v[144:159], v[84:87], v[92:95], v[144:159]
    s_waitcnt lgkmcnt(6)
    v_mfma_f32_32x32x16_bf16 v[96:111], v[32:35], v[40:43], v[96:111]
    ds_read_b64_tr_b16 v[64:65], v10 offset:8192
    ds_read_b64_tr_b16 v[66:67], v10 offset:10240
    v_mfma_f32_32x32x16_bf16 v[112:127], v[32:35], v[44:47], v[112:127]
    ds_read_b128 v[72:75], v9 offset:2048
    ds_read_b64_tr_b16 v[68:69], v10 offset:8448
    v_mfma_f32_32x32x16_bf16 v[128:143], v[36:39], v[40:43], v[128:143]
    ds_read_b64_tr_b16 v[70:71], v10 offset:10496
    ds_read_b128 v[76:79], v9 offset:6144
    v_mfma_f32_32x32x16_bf16 v[144:159], v[36:39], v[44:47], v[144:159]
    s_waitcnt lgkmcnt(6)
    v_mfma_f32_32x32x16_bf16 v[96:111], v[48:51], v[56:59], v[96:111]
    ds_read_b64_tr_b16 v[80:81], v10 offset:12288
    ds_read_b64_tr_b16 v[82:83], v10 offset:14336
    v_mfma_f32_32x32x16_bf16 v[112:127], v[48:51], v[60:63], v[112:127]
    ds_read_b128 v[88:91], v9 offset:3072
    ds_read_b64_tr_b16 v[84:85], v10 offset:12544
    v_mfma_f32_32x32x16_bf16 v[128:143], v[52:55], v[56:59], v[128:143]
    ds_read_b64_tr_b16 v[86:87], v10 offset:14592
    ds_read_b128 v[92:95], v9 offset:7168
    v_mfma_f32_32x32x16_bf16 v[144:159], v[52:55], v[60:63], v[144:159]
    s_waitcnt lgkmcnt(0)
    v_mfma_f32_32x32x16_bf16 v[96:111], v[64:67], v[72:75], v[96:111]
    v_mfma_f32_32x32x16_bf16 v[112:127], v[64:67], v[76:79], v[112:127]
    s_barrier
    ds_read_b64_tr_b16 v[32:33], v10 offset:16384
    ds_read_b64_tr_b16 v[34:35], v10 offset:18432
    ds_read_b128 v[40:43], v9 offset:16384
    v_mfma_f32_32x32x16_bf16 v[128:143], v[68:71], v[72:75], v[128:143]
    ds_read_b64_tr_b16 v[36:37], v10 offset:16640
    ds_read_b64_tr_b16 v[38:39], v10 offset:18688
    ds_read_b128 v[44:47], v9 offset:20480
    v_mfma_f32_32x32x16_bf16 v[144:159], v[68:71], v[76:79], v[144:159]
    v_mfma_f32_32x32x16_bf16 v[96:111], v[80:83], v[88:91], v[96:111]
    ds_read_b64_tr_b16 v[48:49], v10 offset:20480
    ds_read_b64_tr_b16 v[50:51], v10 offset:22528
    v_mfma_f32_32x32x16_bf16 v[112:127], v[80:83], v[92:95], v[112:127]
    ds_read_b128 v[56:59], v9 offset:17408
    ds_read_b64_tr_b16 v[52:53], v10 offset:20736
    v_mfma_f32_32x32x16_bf16 v[128:143], v[84:87], v[88:91], v[128:143]
    ds_read_b64_tr_b16 v[54:55], v10 offset:22784
    ds_read_b128 v[60:63], v9 offset:21504
    v_mfma_f32_32x32x16_bf16 v[144:159], v[84:87], v[92:95], v[144:159]
    s_waitcnt lgkmcnt(6)
    v_mfma_f32_32x32x16_bf16 v[96:111], v[32:35], v[40:43], v[96:111]
    ds_read_b64_tr_b16 v[64:65], v10 offset:24576
    ds_read_b64_tr_b16 v[66:67], v10 offset:26624
    v_mfma_f32_32x32x16_bf16 v[112:127], v[32:35], v[44:47], v[112:127]
    ds_read_b128 v[72:75], v9 offset:18432
    ds_read_b64_tr_b16 v[68:69], v10 offset:24832
    v_mfma_f32_32x32x16_bf16 v[128:143], v[36:39], v[40:43], v[128:143]
    ds_read_b64_tr_b16 v[70:71], v10 offset:26880
    ds_read_b128 v[76:79], v9 offset:22528
    v_mfma_f32_32x32x16_bf16 v[144:159], v[36:39], v[44:47], v[144:159]
    s_waitcnt lgkmcnt(6)
    v_mfma_f32_32x32x16_bf16 v[96:111], v[48:51], v[56:59], v[96:111]
    ds_read_b64_tr_b16 v[80:81], v10 offset:28672
    ds_read_b64_tr_b16 v[82:83], v10 offset:30720
    v_mfma_f32_32x32x16_bf16 v[112:127], v[48:51], v[60:63], v[112:127]
    ds_read_b128 v[88:91], v9 offset:19456
    ds_read_b64_tr_b16 v[84:85], v10 offset:28928
    v_mfma_f32_32x32x16_bf16 v[128:143], v[52:55], v[56:59], v[128:143]
    ds_read_b64_tr_b16 v[86:87], v10 offset:30976
    ds_read_b128 v[92:95], v9 offset:23552
    v_mfma_f32_32x32x16_bf16 v[144:159], v[52:55], v[60:63], v[144:159]
    s_waitcnt lgkmcnt(0)
    v_mfma_f32_32x32x16_bf16 v[96:111], v[64:67], v[72:75], v[96:111]
    v_mfma_f32_32x32x16_bf16 v[112:127], v[64:67], v[76:79], v[112:127]
    s_barrier
    ds_read_b64_tr_b16 v[32:33], v10 offset:32768
    ds_read_b64_tr_b16 v[34:35], v10 offset:34816
    ds_read_b128 v[40:43], v9 offset:32768
    v_mfma_f32_32x32x16_bf16 v[128:143], v[68:71], v[72:75], v[128:143]
    ds_read_b64_tr_b16 v[36:37], v10 offset:33024
    ds_read_b64_tr_b16 v[38:39], v10 offset:35072
    ds_read_b128 v[44:47], v9 offset:36864
    v_mfma_f32_32x32x16_bf16 v[144:159], v[68:71], v[76:79], v[144:159]
    v_mfma_f32_32x32x16_bf16 v[96:111], v[80:83], v[88:91], v[96:111]
    ds_read_b64_tr_b16 v[48:49], v10 offset:36864
    ds_read_b64_tr_b16 v[50:51], v10 offset:38912
    v_mfma_f32_32x32x16_bf16 v[112:127], v[80:83], v[92:95], v[112:127]
    ds_read_b128 v[56:59], v9 offset:33792
    ds_read_b64_tr_b16 v[52:53], v10 offset:37120
    v_mfma_f32_32x32x16_bf16 v[128:143], v[84:87], v[88:91], v[128:143]
    ds_read_b64_tr_b16 v[54:55], v10 offset:39168
    ds_read_b128 v[60:63], v9 offset:37888
    v_mfma_f32_32x32x16_bf16 v[144:159], v[84:87], v[92:95], v[144:159]
    s_waitcnt lgkmcnt(6)
    v_mfma_f32_32x32x16_bf16 v[96:111], v[32:35], v[40:43], v[96:111]
    ds_read_b64_tr_b16 v[64:65], v10 offset:40960
    ds_read_b64_tr_b16 v[66:67], v10 offset:43008
    v_mfma_f32_32x32x16_bf16 v[112:127], v[32:35], v[44:47], v[112:127]
    ds_read_b128 v[72:75], v9 offset:34816
    ds_read_b64_tr_b16 v[68:69], v10 offset:41216
    v_mfma_f32_32x32x16_bf16 v[128:143], v[36:39], v[40:43], v[128:143]
    ds_read_b64_tr_b16 v[70:71], v10 offset:43264
    ds_read_b128 v[76:79], v9 offset:38912
    v_mfma_f32_32x32x16_bf16 v[144:159], v[36:39], v[44:47], v[144:159]
    s_waitcnt lgkmcnt(6)
    v_mfma_f32_32x32x16_bf16 v[96:111], v[48:51], v[56:59], v[96:111]
    ds_read_b64_tr_b16 v[80:81], v10 offset:45056
    ds_read_b64_tr_b16 v[82:83], v10 offset:47104
    v_mfma_f32_32x32x16_bf16 v[112:127], v[48:51], v[60:63], v[112:127]
    ds_read_b128 v[88:91], v9 offset:35840
    ds_read_b64_tr_b16 v[84:85], v10 offset:45312
    v_mfma_f32_32x32x16_bf16 v[128:143], v[52:55], v[56:59], v[128:143]
    ds_read_b64_tr_b16 v[86:87], v10 offset:47360
    ds_read_b128 v[92:95], v9 offset:39936
    v_mfma_f32_32x32x16_bf16 v[144:159], v[52:55], v[60:63], v[144:159]
    s_waitcnt lgkmcnt(0)
    v_mfma_f32_32x32x16_bf16 v[96:111], v[64:67], v[72:75], v[96:111]
    v_mfma_f32_32x32x16_bf16 v[112:127], v[64:67], v[76:79], v[112:127]
    s_barrier
    ds_read_b64_tr_b16 v[32:33], v10 offset:49152
    ds_read_b64_tr_b16 v[34:35], v10 offset:51200
    ds_read_b128 v[40:43], v9 offset:0
    v_mfma_f32_32x32x16_bf16 v[128:143], v[68:71], v[72:75], v[128:143]
    ds_read_b64_tr_b16 v[36:37], v10 offset:49408
    ds_read_b64_tr_b16 v[38:39], v10 offset:51456
    ds_read_b128 v[44:47], v9 offset:4096
    v_mfma_f32_32x32x16_bf16 v[144:159], v[68:71], v[76:79], v[144:159]
    v_mfma_f32_32x32x16_bf16 v[96:111], v[80:83], v[88:91], v[96:111]
    ds_read_b64_tr_b16 v[48:49], v10 offset:53248
    ds_read_b64_tr_b16 v[50:51], v10 offset:55296
    v_mfma_f32_32x32x16_bf16 v[112:127], v[80:83], v[92:95], v[112:127]
    ds_read_b128 v[56:59], v9 offset:1024
    ds_read_b64_tr_b16 v[52:53], v10 offset:53504
    v_mfma_f32_32x32x16_bf16 v[128:143], v[84:87], v[88:91], v[128:143]
    ds_read_b64_tr_b16 v[54:55], v10 offset:55552
    ds_read_b128 v[60:63], v9 offset:5120
    v_mfma_f32_32x32x16_bf16 v[144:159], v[84:87], v[92:95], v[144:159]
    s_waitcnt lgkmcnt(6)
    v_mfma_f32_32x32x16_bf16 v[96:111], v[32:35], v[40:43], v[96:111]
    ds_read_b64_tr_b16 v[64:65], v10 offset:57344
    ds_read_b64_tr_b16 v[66:67], v10 offset:59392
    ds_read_b32 v196, v17 offset:0
    ds_read_b32 v24, v17 offset:1024
    v_mfma_f32_32x32x16_bf16 v[112:127], v[32:35], v[44:47], v[112:127]
    ds_read_b128 v[72:75], v9 offset:2048
    ds_read_b64_tr_b16 v[68:69], v10 offset:57600
    ds_read_b32 v197, v17 offset:1536
    ds_read_b32 v200, v17 offset:128
    v_mfma_f32_32x32x16_bf16 v[128:143], v[36:39], v[40:43], v[128:143]
    ds_read_b64_tr_b16 v[70:71], v10 offset:59648
    ds_read_b128 v[76:79], v9 offset:6144
    ds_read_b32 v26, v17 offset:1152
    ds_read_b32 v201, v17 offset:1664
    v_mfma_f32_32x32x16_bf16 v[144:159], v[36:39], v[44:47], v[144:159]
    s_lshl_b32 s41, s44, 8
    s_add_u32 s41, s41, 147456
    s_waitcnt lgkmcnt(6)
    v_mfma_f32_32x32x16_bf16 v[96:111], v[48:51], v[56:59], v[96:111]
    ds_read_b64_tr_b16 v[80:81], v10 offset:61440
    ds_read_b64_tr_b16 v[82:83], v10 offset:63488
    v_lshlrev_b32 v11, 4, v2
    v_add_u32 v11, s41, v11
    v_mfma_f32_32x32x16_bf16 v[112:127], v[48:51], v[60:63], v[112:127]
    ds_read_b128 v[88:91], v9 offset:3072
    ds_read_b64_tr_b16 v[84:85], v10 offset:61696
    ds_read_b128 v[160:163], v11 offset:0
    ds_read_b128 v[164:167], v11 offset:32
    v_mfma_f32_32x32x16_bf16 v[128:143], v[52:55], v[56:59], v[128:143]
    ds_read_b64_tr_b16 v[86:87], v10 offset:63744
    ds_read_b128 v[92:95], v9 offset:7168
    ds_read_b128 v[168:171], v11 offset:64
    ds_read_b128 v[172:175], v11 offset:96
    v_mfma_f32_32x32x16_bf16 v[144:159], v[52:55], v[60:63], v[144:159]
    ds_read_b128 v[176:179], v11 offset:128
    ds_read_b128 v[180:183], v11 offset:160
    s_waitcnt lgkmcnt(0)
    v_mfma_f32_32x32x16_bf16 v[96:111], v[64:67], v[72:75], v[96:111]
    ds_read_b128 v[184:187], v11 offset:192
    ds_read_b128 v[188:191], v11 offset:224
    v_mfma_f32_32x32x16_bf16 v[112:127], v[64:67], v[76:79], v[112:127]
    s_barrier
    v_mfma_f32_32x32x16_bf16 v[128:143], v[68:71], v[72:75], v[128:143]
    v_mfma_f32_32x32x16_bf16 v[144:159], v[68:71], v[76:79], v[144:159]
    v_mfma_f32_32x32x16_bf16 v[96:111], v[80:83], v[88:91], v[96:111]
    v_mfma_f32_32x32x16_bf16 v[112:127], v[80:83], v[92:95], v[112:127]
    v_mfma_f32_32x32x16_bf16 v[128:143], v[84:87], v[88:91], v[128:143]
    v_mfma_f32_32x32x16_bf16 v[144:159], v[84:87], v[92:95], v[144:159]
    s_waitcnt lgkmcnt(0)
    v_mov_b32 v25, v24
    v_mul_f32 v28, 0xbfb8aa3b, v196
    v_mul_f32 v20, s56, v196
    v_mov_b32 v29, v28
    v_cndmask_b32 v20, v20, v197, s[58:59]
    v_mov_b32 v21, v20
    v_mov_b32 v27, v26
    v_mul_f32 v30, 0xbfb8aa3b, v200
    v_mul_f32 v22, s56, v200
    v_mov_b32 v31, v30
    v_cndmask_b32 v22, v22, v201, s[58:59]
    v_mov_b32 v23, v22
    s_cmp_eq_u32 s31, 3
    s_cbranch_scc1 L_cw_ffn
    s_lshl_b32 s41, s29, 2
    s_lshl_b32 s42, s45, 1
    s_add_u32 s41, s41, s42
    s_mul_i32 s41, s41, 2560
    s_add_u32 s42, s41, 2560
    v_pk_fma_f32 v[96:97], v[160:161], v[24:25], v[96:97]
    v_pk_fma_f32 v[98:99], v[162:163], v[24:25], v[98:99]
    v_pk_fma_f32 v[100:101], v[164:165], v[24:25], v[100:101]
    v_pk_fma_f32 v[102:103], v[166:167], v[24:25], v[102:103]
    v_pk_fma_f32 v[104:105], v[168:169], v[24:25], v[104:105]
    v_pk_fma_f32 v[106:107], v[170:171], v[24:25], v[106:107]
    v_pk_fma_f32 v[108:109], v[172:173], v[24:25], v[108:109]
    v_pk_fma_f32 v[110:111], v[174:175], v[24:25], v[110:111]
    v_pk_mul_f32 v[96:97], v[96:97], v[20:21]
    v_pk_mul_f32 v[98:99], v[98:99], v[20:21]
    v_pk_mul_f32 v[100:101], v[100:101], v[20:21]
    v_pk_mul_f32 v[102:103], v[102:103], v[20:21]
    v_pk_mul_f32 v[104:105], v[104:105], v[20:21]
    v_pk_mul_f32 v[106:107], v[106:107], v[20:21]
    v_pk_mul_f32 v[108:109], v[108:109], v[20:21]
    v_pk_mul_f32 v[110:111], v[110:111], v[20:21]
    v_cvt_pk_bf16_f32 v32, v96, v97
    v_cvt_pk_bf16_f32 v33, v98, v99
    v_cvt_pk_bf16_f32 v34, v100, v101
    v_cvt_pk_bf16_f32 v35, v102, v103
    v_cvt_pk_bf16_f32 v36, v104, v105
    v_cvt_pk_bf16_f32 v37, v106, v107
    v_cvt_pk_bf16_f32 v38, v108, v109
    v_cvt_pk_bf16_f32 v39, v110, v111
    v_permlane32_swap_b32 v32, v34
    v_permlane32_swap_b32 v33, v35
    v_permlane32_swap_b32 v36, v38
    v_permlane32_swap_b32 v37, v39
    buffer_store_dwordx4 v[32:35], v192, s[24:27], s41 offen sc1
    buffer_store_dwordx4 v[36:39], v193, s[24:27], s41 offen sc1
    v_pk_fma_f32 v[112:113], v[160:161], v[26:27], v[112:113]
    v_pk_fma_f32 v[114:115], v[162:163], v[26:27], v[114:115]
    v_pk_fma_f32 v[116:117], v[164:165], v[26:27], v[116:117]
    v_pk_fma_f32 v[118:119], v[166:167], v[26:27], v[118:119]
    v_pk_fma_f32 v[120:121], v[168:169], v[26:27], v[120:121]
    v_pk_fma_f32 v[122:123], v[170:171], v[26:27], v[122:123]
    v_pk_fma_f32 v[124:125], v[172:173], v[26:27], v[124:125]
    v_pk_fma_f32 v[126:127], v[174:175], v[26:27], v[126:127]
    v_pk_mul_f32 v[112:113], v[112:113], v[22:23]
    v_pk_mul_f32 v[114:115], v[114:115], v[22:23]
    v_pk_mul_f32 v[116:117], v[116:117], v[22:23]
    v_pk_mul_f32 v[118:119], v[118:119], v[22:23]
    v_pk_mul_f32 v[120:121], v[120:121], v[22:23]
    v_pk_mul_f32 v[122:123], v[122:123], v[22:23]
    v_pk_mul_f32 v[124:125], v[124:125], v[22:23]
    v_pk_mul_f32 v[126:127], v[126:127], v[22:23]
    v_cvt_pk_bf16_f32 v40, v112, v113
    v_cvt_pk_bf16_f32 v41, v114, v115
    v_cvt_pk_bf16_f32 v42, v116, v117
    v_cvt_pk_bf16_f32 v43, v118, v119
    v_cvt_pk_bf16_f32 v44, v120, v121
    v_cvt_pk_bf16_f32 v45, v122, v123
    v_cvt_pk_bf16_f32 v46, v124, v125
    v_cvt_pk_bf16_f32 v47, v126, v127
    v_permlane32_swap_b32 v40, v42
    v_permlane32_swap_b32 v41, v43
    v_permlane32_swap_b32 v44, v46
    v_permlane32_swap_b32 v45, v47
    buffer_store_dwordx4 v[40:43], v192, s[24:27], s42 offen sc1
    buffer_store_dwordx4 v[44:47], v193, s[24:27], s42 offen sc1
    v_pk_fma_f32 v[128:129], v[176:177], v[24:25], v[128:129]
    v_pk_fma_f32 v[130:131], v[178:179], v[24:25], v[130:131]
    v_pk_fma_f32 v[132:133], v[180:181], v[24:25], v[132:133]
    v_pk_fma_f32 v[134:135], v[182:183], v[24:25], v[134:135]
    v_pk_fma_f32 v[136:137], v[184:185], v[24:25], v[136:137]
    v_pk_fma_f32 v[138:139], v[186:187], v[24:25], v[138:139]
    v_pk_fma_f32 v[140:141], v[188:189], v[24:25], v[140:141]
    v_pk_fma_f32 v[142:143], v[190:191], v[24:25], v[142:143]
    v_pk_mul_f32 v[128:129], v[128:129], v[20:21]
    v_pk_mul_f32 v[130:131], v[130:131], v[20:21]
    v_pk_mul_f32 v[132:133], v[132:133], v[20:21]
    v_pk_mul_f32 v[134:135], v[134:135], v[20:21]
    v_pk_mul_f32 v[136:137], v[136:137], v[20:21]
    v_pk_mul_f32 v[138:139], v[138:139], v[20:21]
    v_pk_mul_f32 v[140:141], v[140:141], v[20:21]
    v_pk_mul_f32 v[142:143], v[142:143], v[20:21]
    v_cvt_pk_bf16_f32 v48, v128, v129
    v_cvt_pk_bf16_f32 v49, v130, v131
    v_cvt_pk_bf16_f32 v50, v132, v133
    v_cvt_pk_bf16_f32 v51, v134, v135
    v_cvt_pk_bf16_f32 v52, v136, v137
    v_cvt_pk_bf16_f32 v53, v138, v139
    v_cvt_pk_bf16_f32 v54, v140, v141
    v_cvt_pk_bf16_f32 v55, v142, v143
    v_permlane32_swap_b32 v48, v50
    v_permlane32_swap_b32 v49, v51
    v_permlane32_swap_b32 v52, v54
    v_permlane32_swap_b32 v53, v55
    buffer_store_dwordx4 v[48:51], v194, s[24:27], s41 offen sc1
    buffer_store_dwordx4 v[52:55], v195, s[24:27], s41 offen sc1
    v_pk_fma_f32 v[144:145], v[176:177], v[26:27], v[144:145]
    v_pk_fma_f32 v[146:147], v[178:179], v[26:27], v[146:147]
    v_pk_fma_f32 v[148:149], v[180:181], v[26:27], v[148:149]
    v_pk_fma_f32 v[150:151], v[182:183], v[26:27], v[150:151]
    v_pk_fma_f32 v[152:153], v[184:185], v[26:27], v[152:153]
    v_pk_fma_f32 v[154:155], v[186:187], v[26:27], v[154:155]
    v_pk_fma_f32 v[156:157], v[188:189], v[26:27], v[156:157]
    v_pk_fma_f32 v[158:159], v[190:191], v[26:27], v[158:159]
    v_pk_mul_f32 v[144:145], v[144:145], v[22:23]
    v_pk_mul_f32 v[146:147], v[146:147], v[22:23]
    v_pk_mul_f32 v[148:149], v[148:149], v[22:23]
    v_pk_mul_f32 v[150:151], v[150:151], v[22:23]
    v_pk_mul_f32 v[152:153], v[152:153], v[22:23]
    v_pk_mul_f32 v[154:155], v[154:155], v[22:23]
    v_pk_mul_f32 v[156:157], v[156:157], v[22:23]
    v_pk_mul_f32 v[158:159], v[158:159], v[22:23]
    v_cvt_pk_bf16_f32 v56, v144, v145
    v_cvt_pk_bf16_f32 v57, v146, v147
    v_cvt_pk_bf16_f32 v58, v148, v149
    v_cvt_pk_bf16_f32 v59, v150, v151
    v_cvt_pk_bf16_f32 v60, v152, v153
    v_cvt_pk_bf16_f32 v61, v154, v155
    v_cvt_pk_bf16_f32 v62, v156, v157
    v_cvt_pk_bf16_f32 v63, v158, v159
    v_permlane32_swap_b32 v56, v58
    v_permlane32_swap_b32 v57, v59
    v_permlane32_swap_b32 v60, v62
    v_permlane32_swap_b32 v61, v63
    buffer_store_dwordx4 v[56:59], v194, s[24:27], s42 offen sc1
    buffer_store_dwordx4 v[60:63], v195, s[24:27], s42 offen sc1
    s_branch L_cw_fin
L_cw_ffn:
    s_lshl_b32 s41, s44, 6
    s_add_u32 s41, s41, s39
    s_cmp_ge_u32 s41, 1728
    s_cbranch_scc1 L_cw_fin
    s_lshr_b32 s41, s41, 4
    s_lshl_b32 s42, s29, 2
    s_lshl_b32 s43, s45, 1
    s_add_u32 s42, s42, s43
    s_mul_i32 s42, s42, 108
    s_add_u32 s41, s41, s42
    s_lshl_b32 s41, s41, 10
    s_add_u32 s42, s41, 110592
    v_pk_fma_f32 v[96:97], v[160:161], v[24:25], v[96:97]
    v_pk_fma_f32 v[98:99], v[162:163], v[24:25], v[98:99]
    v_pk_fma_f32 v[100:101], v[164:165], v[24:25], v[100:101]
    v_pk_fma_f32 v[102:103], v[166:167], v[24:25], v[102:103]
    v_pk_fma_f32 v[104:105], v[168:169], v[24:25], v[104:105]
    v_pk_fma_f32 v[106:107], v[170:171], v[24:25], v[106:107]
    v_pk_fma_f32 v[108:109], v[172:173], v[24:25], v[108:109]
    v_pk_fma_f32 v[110:111], v[174:175], v[24:25], v[110:111]
    v_pk_mul_f32 v[196:197], v[96:97], v[28:29]
    v_pk_mul_f32 v[198:199], v[98:99], v[28:29]
    v_pk_mul_f32 v[200:201], v[100:101], v[28:29]
    v_pk_mul_f32 v[202:203], v[102:103], v[28:29]
    v_pk_mul_f32 v[204:205], v[104:105], v[28:29]
    v_pk_mul_f32 v[206:207], v[106:107], v[28:29]
    v_pk_mul_f32 v[208:209], v[108:109], v[28:29]
    v_pk_mul_f32 v[210:211], v[110:111], v[28:29]
    v_exp_f32 v196, v196
    v_exp_f32 v197, v197
    v_exp_f32 v198, v198
    v_exp_f32 v199, v199
    v_exp_f32 v200, v200
    v_exp_f32 v201, v201
    v_exp_f32 v202, v202
    v_exp_f32 v203, v203
    v_exp_f32 v204, v204
    v_exp_f32 v205, v205
    v_exp_f32 v206, v206
    v_exp_f32 v207, v207
    v_exp_f32 v208, v208
    v_exp_f32 v209, v209
    v_exp_f32 v210, v210
    v_exp_f32 v211, v211
    v_pk_fma_f32 v[196:197], v[196:197], v[20:21], v[20:21]
    v_pk_fma_f32 v[198:199], v[198:199], v[20:21], v[20:21]
    v_pk_fma_f32 v[200:201], v[200:201], v[20:21], v[20:21]
    v_pk_fma_f32 v[202:203], v[202:203], v[20:21], v[20:21]
    v_pk_fma_f32 v[204:205], v[204:205], v[20:21], v[20:21]
    v_pk_fma_f32 v[206:207], v[206:207], v[20:21], v[20:21]
    v_pk_fma_f32 v[208:209], v[208:209], v[20:21], v[20:21]
    v_pk_fma_f32 v[210:211], v[210:211], v[20:21], v[20:21]
    v_rcp_f32 v196, v196
    v_rcp_f32 v197, v197
    v_rcp_f32 v198, v198
    v_rcp_f32 v199, v199
    v_rcp_f32 v200, v200
    v_rcp_f32 v201, v201
    v_rcp_f32 v202, v202
    v_rcp_f32 v203, v203
    v_rcp_f32 v204, v204
    v_rcp_f32 v205, v205
    v_rcp_f32 v206, v206
    v_rcp_f32 v207, v207
    v_rcp_f32 v208, v208
    v_rcp_f32 v209, v209
    v_rcp_f32 v210, v210
    v_rcp_f32 v211, v211
    v_pk_mul_f32 v[96:97], v[96:97], v[196:197]
    v_pk_mul_f32 v[98:99], v[98:99], v[198:199]
    v_pk_mul_f32 v[100:101], v[100:101], v[200:201]
    v_pk_mul_f32 v[102:103], v[102:103], v[202:203]
    v_pk_mul_f32 v[104:105], v[104:105], v[204:205]
    v_pk_mul_f32 v[106:107], v[106:107], v[206:207]
    v_pk_mul_f32 v[108:109], v[108:109], v[208:209]
    v_pk_mul_f32 v[110:111], v[110:111], v[210:211]
    v_cvt_pk_bf16_f32 v32, v96, v97
    v_cvt_pk_bf16_f32 v33, v98, v99
    v_cvt_pk_bf16_f32 v34, v100, v101
    v_cvt_pk_bf16_f32 v35, v102, v103
    v_cvt_pk_bf16_f32 v36, v104, v105
    v_cvt_pk_bf16_f32 v37, v106, v107
    v_cvt_pk_bf16_f32 v38, v108, v109
    v_cvt_pk_bf16_f32 v39, v110, v111
    buffer_store_dwordx4 v[32:35], v4, s[24:27], s41 offen sc1
    buffer_store_dwordx4 v[36:39], v4, s[24:27], s41 offen offset:1024 sc1
    v_pk_fma_f32 v[128:129], v[176:177], v[24:25], v[128:129]
    v_pk_fma_f32 v[130:131], v[178:179], v[24:25], v[130:131]
    v_pk_fma_f32 v[132:133], v[180:181], v[24:25], v[132:133]
    v_pk_fma_f32 v[134:135], v[182:183], v[24:25], v[134:135]
    v_pk_fma_f32 v[136:137], v[184:185], v[24:25], v[136:137]
    v_pk_fma_f32 v[138:139], v[186:187], v[24:25], v[138:139]
    v_pk_fma_f32 v[140:141], v[188:189], v[24:25], v[140:141]
    v_pk_fma_f32 v[142:143], v[190:191], v[24:25], v[142:143]
    v_pk_mul_f32 v[196:197], v[128:129], v[28:29]
    v_pk_mul_f32 v[198:199], v[130:131], v[28:29]
    v_pk_mul_f32 v[200:201], v[132:133], v[28:29]
    v_pk_mul_f32 v[202:203], v[134:135], v[28:29]
    v_pk_mul_f32 v[204:205], v[136:137], v[28:29]
    v_pk_mul_f32 v[206:207], v[138:139], v[28:29]
    v_pk_mul_f32 v[208:209], v[140:141], v[28:29]
    v_pk_mul_f32 v[210:211], v[142:143], v[28:29]
    v_exp_f32 v196, v196
    v_exp_f32 v197, v197
    v_exp_f32 v198, v198
    v_exp_f32 v199, v199
    v_exp_f32 v200, v200
    v_exp_f32 v201, v201
    v_exp_f32 v202, v202
    v_exp_f32 v203, v203
    v_exp_f32 v204, v204
    v_exp_f32 v205, v205
    v_exp_f32 v206, v206
    v_exp_f32 v207, v207
    v_exp_f32 v208, v208
    v_exp_f32 v209, v209
    v_exp_f32 v210, v210
    v_exp_f32 v211, v211
    v_pk_fma_f32 v[196:197], v[196:197], v[20:21], v[20:21]
    v_pk_fma_f32 v[198:199], v[198:199], v[20:21], v[20:21]
    v_pk_fma_f32 v[200:201], v[200:201], v[20:21], v[20:21]
    v_pk_fma_f32 v[202:203], v[202:203], v[20:21], v[20:21]
    v_pk_fma_f32 v[204:205], v[204:205], v[20:21], v[20:21]
    v_pk_fma_f32 v[206:207], v[206:207], v[20:21], v[20:21]
    v_pk_fma_f32 v[208:209], v[208:209], v[20:21], v[20:21]
    v_pk_fma_f32 v[210:211], v[210:211], v[20:21], v[20:21]
    v_rcp_f32 v196, v196
    v_rcp_f32 v197, v197
    v_rcp_f32 v198, v198
    v_rcp_f32 v199, v199
    v_rcp_f32 v200, v200
    v_rcp_f32 v201, v201
    v_rcp_f32 v202, v202
    v_rcp_f32 v203, v203
    v_rcp_f32 v204, v204
    v_rcp_f32 v205, v205
    v_rcp_f32 v206, v206
    v_rcp_f32 v207, v207
    v_rcp_f32 v208, v208
    v_rcp_f32 v209, v209
    v_rcp_f32 v210, v210
    v_rcp_f32 v211, v211
    v_pk_mul_f32 v[128:129], v[128:129], v[196:197]
    v_pk_mul_f32 v[130:131], v[130:131], v[198:199]
    v_pk_mul_f32 v[132:133], v[132:133], v[200:201]
    v_pk_mul_f32 v[134:135], v[134:135], v[202:203]
    v_pk_mul_f32 v[136:137], v[136:137], v[204:205]
    v_pk_mul_f32 v[138:139], v[138:139], v[206:207]
    v_pk_mul_f32 v[140:141], v[140:141], v[208:209]
    v_pk_mul_f32 v[142:143], v[142:143], v[210:211]
    v_cvt_pk_bf16_f32 v40, v128, v129
    v_cvt_pk_bf16_f32 v41, v130, v131
    v_cvt_pk_bf16_f32 v42, v132, v133
    v_cvt_pk_bf16_f32 v43, v134, v135
    v_cvt_pk_bf16_f32 v44, v136, v137
    v_cvt_pk_bf16_f32 v45, v138, v139
    v_cvt_pk_bf16_f32 v46, v140, v141
    v_cvt_pk_bf16_f32 v47, v142, v143
    buffer_store_dwordx4 v[40:43], v4, s[24:27], s41 offen offset:2048 sc1
    buffer_store_dwordx4 v[44:47], v4, s[24:27], s41 offen offset:3072 sc1
    v_pk_fma_f32 v[112:113], v[160:161], v[26:27], v[112:113]
    v_pk_fma_f32 v[114:115], v[162:163], v[26:27], v[114:115]
    v_pk_fma_f32 v[116:117], v[164:165], v[26:27], v[116:117]
    v_pk_fma_f32 v[118:119], v[166:167], v[26:27], v[118:119]
    v_pk_fma_f32 v[120:121], v[168:169], v[26:27], v[120:121]
    v_pk_fma_f32 v[122:123], v[170:171], v[26:27], v[122:123]
    v_pk_fma_f32 v[124:125], v[172:173], v[26:27], v[124:125]
    v_pk_fma_f32 v[126:127], v[174:175], v[26:27], v[126:127]
    v_pk_mul_f32 v[196:197], v[112:113], v[30:31]
    v_pk_mul_f32 v[198:199], v[114:115], v[30:31]
    v_pk_mul_f32 v[200:201], v[116:117], v[30:31]
    v_pk_mul_f32 v[202:203], v[118:119], v[30:31]
    v_pk_mul_f32 v[204:205], v[120:121], v[30:31]
    v_pk_mul_f32 v[206:207], v[122:123], v[30:31]
    v_pk_mul_f32 v[208:209], v[124:125], v[30:31]
    v_pk_mul_f32 v[210:211], v[126:127], v[30:31]
    v_exp_f32 v196, v196
    v_exp_f32 v197, v197
    v_exp_f32 v198, v198
    v_exp_f32 v199, v199
    v_exp_f32 v200, v200
    v_exp_f32 v201, v201
    v_exp_f32 v202, v202
    v_exp_f32 v203, v203
    v_exp_f32 v204, v204
    v_exp_f32 v205, v205
    v_exp_f32 v206, v206
    v_exp_f32 v207, v207
    v_exp_f32 v208, v208
    v_exp_f32 v209, v209
    v_exp_f32 v210, v210
    v_exp_f32 v211, v211
    v_pk_fma_f32 v[196:197], v[196:197], v[22:23], v[22:23]
    v_pk_fma_f32 v[198:199], v[198:199], v[22:23], v[22:23]
    v_pk_fma_f32 v[200:201], v[200:201], v[22:23], v[22:23]
    v_pk_fma_f32 v[202:203], v[202:203], v[22:23], v[22:23]
    v_pk_fma_f32 v[204:205], v[204:205], v[22:23], v[22:23]
    v_pk_fma_f32 v[206:207], v[206:207], v[22:23], v[22:23]
    v_pk_fma_f32 v[208:209], v[208:209], v[22:23], v[22:23]
    v_pk_fma_f32 v[210:211], v[210:211], v[22:23], v[22:23]
    v_rcp_f32 v196, v196
    v_rcp_f32 v197, v197
    v_rcp_f32 v198, v198
    v_rcp_f32 v199, v199
    v_rcp_f32 v200, v200
    v_rcp_f32 v201, v201
    v_rcp_f32 v202, v202
    v_rcp_f32 v203, v203
    v_rcp_f32 v204, v204
    v_rcp_f32 v205, v205
    v_rcp_f32 v206, v206
    v_rcp_f32 v207, v207
    v_rcp_f32 v208, v208
    v_rcp_f32 v209, v209
    v_rcp_f32 v210, v210
    v_rcp_f32 v211, v211
    v_pk_mul_f32 v[112:113], v[112:113], v[196:197]
    v_pk_mul_f32 v[114:115], v[114:115], v[198:199]
    v_pk_mul_f32 v[116:117], v[116:117], v[200:201]
    v_pk_mul_f32 v[118:119], v[118:119], v[202:203]
    v_pk_mul_f32 v[120:121], v[120:121], v[204:205]
    v_pk_mul_f32 v[122:123], v[122:123], v[206:207]
    v_pk_mul_f32 v[124:125], v[124:125], v[208:209]
    v_pk_mul_f32 v[126:127], v[126:127], v[210:211]
    v_cvt_pk_bf16_f32 v48, v112, v113
    v_cvt_pk_bf16_f32 v49, v114, v115
    v_cvt_pk_bf16_f32 v50, v116, v117
    v_cvt_pk_bf16_f32 v51, v118, v119
    v_cvt_pk_bf16_f32 v52, v120, v121
    v_cvt_pk_bf16_f32 v53, v122, v123
    v_cvt_pk_bf16_f32 v54, v124, v125
    v_cvt_pk_bf16_f32 v55, v126, v127
    buffer_store_dwordx4 v[48:51], v4, s[24:27], s42 offen sc1
    buffer_store_dwordx4 v[52:55], v4, s[24:27], s42 offen offset:1024 sc1
    v_pk_fma_f32 v[144:145], v[176:177], v[26:27], v[144:145]
    v_pk_fma_f32 v[146:147], v[178:179], v[26:27], v[146:147]
    v_pk_fma_f32 v[148:149], v[180:181], v[26:27], v[148:149]
    v_pk_fma_f32 v[150:151], v[182:183], v[26:27], v[150:151]
    v_pk_fma_f32 v[152:153], v[184:185], v[26:27], v[152:153]
    v_pk_fma_f32 v[154:155], v[186:187], v[26:27], v[154:155]
    v_pk_fma_f32 v[156:157], v[188:189], v[26:27], v[156:157]
    v_pk_fma_f32 v[158:159], v[190:191], v[26:27], v[158:159]
    v_pk_mul_f32 v[196:197], v[144:145], v[30:31]
    v_pk_mul_f32 v[198:199], v[146:147], v[30:31]
    v_pk_mul_f32 v[200:201], v[148:149], v[30:31]
    v_pk_mul_f32 v[202:203], v[150:151], v[30:31]
    v_pk_mul_f32 v[204:205], v[152:153], v[30:31]
    v_pk_mul_f32 v[206:207], v[154:155], v[30:31]
    v_pk_mul_f32 v[208:209], v[156:157], v[30:31]
    v_pk_mul_f32 v[210:211], v[158:159], v[30:31]
    v_exp_f32 v196, v196
    v_exp_f32 v197, v197
    v_exp_f32 v198, v198
    v_exp_f32 v199, v199
    v_exp_f32 v200, v200
    v_exp_f32 v201, v201
    v_exp_f32 v202, v202
    v_exp_f32 v203, v203
    v_exp_f32 v204, v204
    v_exp_f32 v205, v205
    v_exp_f32 v206, v206
    v_exp_f32 v207, v207
    v_exp_f32 v208, v208
    v_exp_f32 v209, v209
    v_exp_f32 v210, v210
    v_exp_f32 v211, v211
    v_pk_fma_f32 v[196:197], v[196:197], v[22:23], v[22:23]
    v_pk_fma_f32 v[198:199], v[198:199], v[22:23], v[22:23]
    v_pk_fma_f32 v[200:201], v[200:201], v[22:23], v[22:23]
    v_pk_fma_f32 v[202:203], v[202:203], v[22:23], v[22:23]
    v_pk_fma_f32 v[204:205], v[204:205], v[22:23], v[22:23]
    v_pk_fma_f32 v[206:207], v[206:207], v[22:23], v[22:23]
    v_pk_fma_f32 v[208:209], v[208:209], v[22:23], v[22:23]
    v_pk_fma_f32 v[210:211], v[210:211], v[22:23], v[22:23]
    v_rcp_f32 v196, v196
    v_rcp_f32 v197, v197
    v_rcp_f32 v198, v198
    v_rcp_f32 v199, v199
    v_rcp_f32 v200, v200
    v_rcp_f32 v201, v201
    v_rcp_f32 v202, v202
    v_rcp_f32 v203, v203
    v_rcp_f32 v204, v204
    v_rcp_f32 v205, v205
    v_rcp_f32 v206, v206
    v_rcp_f32 v207, v207
    v_rcp_f32 v208, v208
    v_rcp_f32 v209, v209
    v_rcp_f32 v210, v210
    v_rcp_f32 v211, v211
    v_pk_mul_f32 v[144:145], v[144:145], v[196:197]
    v_pk_mul_f32 v[146:147], v[146:147], v[198:199]
    v_pk_mul_f32 v[148:149], v[148:149], v[200:201]
    v_pk_mul_f32 v[150:151], v[150:151], v[202:203]
    v_pk_mul_f32 v[152:153], v[152:153], v[204:205]
    v_pk_mul_f32 v[154:155], v[154:155], v[206:207]
    v_pk_mul_f32 v[156:157], v[156:157], v[208:209]
    v_pk_mul_f32 v[158:159], v[158:159], v[210:211]
    v_cvt_pk_bf16_f32 v56, v144, v145
    v_cvt_pk_bf16_f32 v57, v146, v147
    v_cvt_pk_bf16_f32 v58, v148, v149
    v_cvt_pk_bf16_f32 v59, v150, v151
    v_cvt_pk_bf16_f32 v60, v152, v153
    v_cvt_pk_bf16_f32 v61, v154, v155
    v_cvt_pk_bf16_f32 v62, v156, v157
    v_cvt_pk_bf16_f32 v63, v158, v159
    buffer_store_dwordx4 v[56:59], v4, s[24:27], s42 offen offset:2048 sc1
    buffer_store_dwordx4 v[60:63], v4, s[24:27], s42 offen offset:3072 sc1
    s_branch L_cw_fin
L_cw_vmode:
.p2align 6
    s_waitcnt lgkmcnt(6)
    v_mfma_f32_32x32x16_bf16 v[96:111], v[40:43], v[32:35], v[96:111]
    ds_read_b64_tr_b16 v[64:65], v10 offset:8192
    ds_read_b64_tr_b16 v[66:67], v10 offset:10240
    v_mfma_f32_32x32x16_bf16 v[112:127], v[44:47], v[32:35], v[112:127]
    ds_read_b128 v[72:75], v9 offset:2048
    ds_read_b64_tr_b16 v[68:69], v10 offset:8448
    v_mfma_f32_32x32x16_bf16 v[128:143], v[40:43], v[36:39], v[128:143]
    ds_read_b64_tr_b16 v[70:71], v10 offset:10496
    ds_read_b128 v[76:79], v9 offset:6144
    v_mfma_f32_32x32x16_bf16 v[144:159], v[44:47], v[36:39], v[144:159]
    s_waitcnt lgkmcnt(6)
    v_mfma_f32_32x32x16_bf16 v[96:111], v[56:59], v[48:51], v[96:111]
    ds_read_b64_tr_b16 v[80:81], v10 offset:12288
    ds_read_b64_tr_b16 v[82:83], v10 offset:14336
    v_mfma_f32_32x32x16_bf16 v[112:127], v[60:63], v[48:51], v[112:127]
    ds_read_b128 v[88:91], v9 offset:3072
    ds_read_b64_tr_b16 v[84:85], v10 offset:12544
    v_mfma_f32_32x32x16_bf16 v[128:143], v[56:59], v[52:55], v[128:143]
    ds_read_b64_tr_b16 v[86:87], v10 offset:14592
    ds_read_b128 v[92:95], v9 offset:7168
    v_mfma_f32_32x32x16_bf16 v[144:159], v[60:63], v[52:55], v[144:159]
    s_waitcnt lgkmcnt(0)
    v_mfma_f32_32x32x16_bf16 v[96:111], v[72:75], v[64:67], v[96:111]
    v_mfma_f32_32x32x16_bf16 v[112:127], v[76:79], v[64:67], v[112:127]
    s_barrier
    ds_read_b64_tr_b16 v[32:33], v10 offset:16384
    ds_read_b64_tr_b16 v[34:35], v10 offset:18432
    ds_read_b128 v[40:43], v9 offset:16384
    v_mfma_f32_32x32x16_bf16 v[128:143], v[72:75], v[68:71], v[128:143]
    ds_read_b64_tr_b16 v[36:37], v10 offset:16640
    ds_read_b64_tr_b16 v[38:39], v10 offset:18688
    ds_read_b128 v[44:47], v9 offset:20480
    v_mfma_f32_32x32x16_bf16 v[144:159], v[76:79], v[68:71], v[144:159]
    v_mfma_f32_32x32x16_bf16 v[96:111], v[88:91], v[80:83], v[96:111]
    ds_read_b64_tr_b16 v[48:49], v10 offset:20480
    ds_read_b64_tr_b16 v[50:51], v10 offset:22528
    v_mfma_f32_32x32x16_bf16 v[112:127], v[92:95], v[80:83], v[112:127]
    ds_read_b128 v[56:59], v9 offset:17408
    ds_read_b64_tr_b16 v[52:53], v10 offset:20736
    v_mfma_f32_32x32x16_bf16 v[128:143], v[88:91], v[84:87], v[128:143]
    ds_read_b64_tr_b16 v[54:55], v10 offset:22784
    ds_read_b128 v[60:63], v9 offset:21504
    v_mfma_f32_32x32x16_bf16 v[144:159], v[92:95], v[84:87], v[144:159]
    s_waitcnt lgkmcnt(6)
    v_mfma_f32_32x32x16_bf16 v[96:111], v[40:43], v[32:35], v[96:111]
    ds_read_b64_tr_b16 v[64:65], v10 offset:24576
    ds_read_b64_tr_b16 v[66:67], v10 offset:26624
    v_mfma_f32_32x32x16_bf16 v[112:127], v[44:47], v[32:35], v[112:127]
    ds_read_b128 v[72:75], v9 offset:18432
    ds_read_b64_tr_b16 v[68:69], v10 offset:24832
    v_mfma_f32_32x32x16_bf16 v[128:143], v[40:43], v[36:39], v[128:143]
    ds_read_b64_tr_b16 v[70:71], v10 offset:26880
    ds_read_b128 v[76:79], v9 offset:22528
    v_mfma_f32_32x32x16_bf16 v[144:159], v[44:47], v[36:39], v[144:159]
    s_waitcnt lgkmcnt(6)
    v_mfma_f32_32x32x16_bf16 v[96:111], v[56:59], v[48:51], v[96:111]
    ds_read_b64_tr_b16 v[80:81], v10 offset:28672
    ds_read_b64_tr_b16 v[82:83], v10 offset:30720
    v_mfma_f32_32x32x16_bf16 v[112:127], v[60:63], v[48:51], v[112:127]
    ds_read_b128 v[88:91], v9 offset:19456
    ds_read_b64_tr_b16 v[84:85], v10 offset:28928
    v_mfma_f32_32x32x16_bf16 v[128:143], v[56:59], v[52:55], v[128:143]
    ds_read_b64_tr_b16 v[86:87], v10 offset:30976
    ds_read_b128 v[92:95], v9 offset:23552
    v_mfma_f32_32x32x16_bf16 v[144:159], v[60:63], v[52:55], v[144:159]
    s_waitcnt lgkmcnt(0)
    v_mfma_f32_32x32x16_bf16 v[96:111], v[72:75], v[64:67], v[96:111]
    v_mfma_f32_32x32x16_bf16 v[112:127], v[76:79], v[64:67], v[112:127]
    s_barrier
    ds_read_b64_tr_b16 v[32:33], v10 offset:32768
    ds_read_b64_tr_b16 v[34:35], v10 offset:34816
    ds_read_b128 v[40:43], v9 offset:32768
    v_mfma_f32_32x32x16_bf16 v[128:143], v[72:75], v[68:71], v[128:143]
    ds_read_b64_tr_b16 v[36:37], v10 offset:33024
    ds_read_b64_tr_b16 v[38:39], v10 offset:35072
    ds_read_b128 v[44:47], v9 offset:36864
    v_mfma_f32_32x32x16_bf16 v[144:159], v[76:79], v[68:71], v[144:159]
    v_mfma_f32_32x32x16_bf16 v[96:111], v[88:91], v[80:83], v[96:111]
    ds_read_b64_tr_b16 v[48:49], v10 offset:36864
    ds_read_b64_tr_b16 v[50:51], v10 offset:38912
    v_mfma_f32_32x32x16_bf16 v[112:127], v[92:95], v[80:83], v[112:127]
    ds_read_b128 v[56:59], v9 offset:33792
    ds_read_b64_tr_b16 v[52:53], v10 offset:37120
    v_mfma_f32_32x32x16_bf16 v[128:143], v[88:91], v[84:87], v[128:143]
    ds_read_b64_tr_b16 v[54:55], v10 offset:39168
    ds_read_b128 v[60:63], v9 offset:37888
    v_mfma_f32_32x32x16_bf16 v[144:159], v[92:95], v[84:87], v[144:159]
    s_waitcnt lgkmcnt(6)
    v_mfma_f32_32x32x16_bf16 v[96:111], v[40:43], v[32:35], v[96:111]
    ds_read_b64_tr_b16 v[64:65], v10 offset:40960
    ds_read_b64_tr_b16 v[66:67], v10 offset:43008
    v_mfma_f32_32x32x16_bf16 v[112:127], v[44:47], v[32:35], v[112:127]
    ds_read_b128 v[72:75], v9 offset:34816
    ds_read_b64_tr_b16 v[68:69], v10 offset:41216
    v_mfma_f32_32x32x16_bf16 v[128:143], v[40:43], v[36:39], v[128:143]
    ds_read_b64_tr_b16 v[70:71], v10 offset:43264
    ds_read_b128 v[76:79], v9 offset:38912
    v_mfma_f32_32x32x16_bf16 v[144:159], v[44:47], v[36:39], v[144:159]
    s_waitcnt lgkmcnt(6)
    v_mfma_f32_32x32x16_bf16 v[96:111], v[56:59], v[48:51], v[96:111]
    ds_read_b64_tr_b16 v[80:81], v10 offset:45056
    ds_read_b64_tr_b16 v[82:83], v10 offset:47104
    v_mfma_f32_32x32x16_bf16 v[112:127], v[60:63], v[48:51], v[112:127]
    ds_read_b128 v[88:91], v9 offset:35840
    ds_read_b64_tr_b16 v[84:85], v10 offset:45312
    v_mfma_f32_32x32x16_bf16 v[128:143], v[56:59], v[52:55], v[128:143]
    ds_read_b64_tr_b16 v[86:87], v10 offset:47360
    ds_read_b128 v[92:95], v9 offset:39936
    v_mfma_f32_32x32x16_bf16 v[144:159], v[60:63], v[52:55], v[144:159]
    s_waitcnt lgkmcnt(0)
    v_mfma_f32_32x32x16_bf16 v[96:111], v[72:75], v[64:67], v[96:111]
    v_mfma_f32_32x32x16_bf16 v[112:127], v[76:79], v[64:67], v[112:127]
    s_barrier
    ds_read_b64_tr_b16 v[32:33], v10 offset:49152
    ds_read_b64_tr_b16 v[34:35], v10 offset:51200
    ds_read_b128 v[40:43], v9 offset:0
    v_mfma_f32_32x32x16_bf16 v[128:143], v[72:75], v[68:71], v[128:143]
    ds_read_b64_tr_b16 v[36:37], v10 offset:49408
    ds_read_b64_tr_b16 v[38:39], v10 offset:51456
    ds_read_b128 v[44:47], v9 offset:4096
    v_mfma_f32_32x32x16_bf16 v[144:159], v[76:79], v[68:71], v[144:159]
    v_mfma_f32_32x32x16_bf16 v[96:111], v[88:91], v[80:83], v[96:111]
    ds_read_b64_tr_b16 v[48:49], v10 offset:53248
    ds_read_b64_tr_b16 v[50:51], v10 offset:55296
    v_mfma_f32_32x32x16_bf16 v[112:127], v[92:95], v[80:83], v[112:127]
    ds_read_b128 v[56:59], v9 offset:1024
    ds_read_b64_tr_b16 v[52:53], v10 offset:53504
    v_mfma_f32_32x32x16_bf16 v[128:143], v[88:91], v[84:87], v[128:143]
    ds_read_b64_tr_b16 v[54:55], v10 offset:55552
    ds_read_b128 v[60:63], v9 offset:5120
    v_mfma_f32_32x32x16_bf16 v[144:159], v[92:95], v[84:87], v[144:159]
    s_waitcnt lgkmcnt(6)
    v_mfma_f32_32x32x16_bf16 v[96:111], v[40:43], v[32:35], v[96:111]
    ds_read_b64_tr_b16 v[64:65], v10 offset:57344
    ds_read_b64_tr_b16 v[66:67], v10 offset:59392
    v_mfma_f32_32x32x16_bf16 v[112:127], v[44:47], v[32:35], v[112:127]
    ds_read_b128 v[72:75], v9 offset:2048
    ds_read_b64_tr_b16 v[68:69], v10 offset:57600
    v_mfma_f32_32x32x16_bf16 v[128:143], v[40:43], v[36:39], v[128:143]
    ds_read_b64_tr_b16 v[70:71], v10 offset:59648
    ds_read_b128 v[76:79], v9 offset:6144
    v_mfma_f32_32x32x16_bf16 v[144:159], v[44:47], v[36:39], v[144:159]
    s_waitcnt lgkmcnt(6)
    v_mfma_f32_32x32x16_bf16 v[96:111], v[56:59], v[48:51], v[96:111]
    ds_read_b64_tr_b16 v[80:81], v10 offset:61440
    ds_read_b64_tr_b16 v[82:83], v10 offset:63488
    v_mfma_f32_32x32x16_bf16 v[112:127], v[60:63], v[48:51], v[112:127]
    ds_read_b128 v[88:91], v9 offset:3072
    ds_read_b64_tr_b16 v[84:85], v10 offset:61696
    v_mfma_f32_32x32x16_bf16 v[128:143], v[56:59], v[52:55], v[128:143]
    ds_read_b64_tr_b16 v[86:87], v10 offset:63744
    ds_read_b128 v[92:95], v9 offset:7168
    v_mfma_f32_32x32x16_bf16 v[144:159], v[60:63], v[52:55], v[144:159]
    s_waitcnt lgkmcnt(0)
    v_mfma_f32_32x32x16_bf16 v[96:111], v[72:75], v[64:67], v[96:111]
    v_mfma_f32_32x32x16_bf16 v[112:127], v[76:79], v[64:67], v[112:127]
    s_barrier
    ds_read_b64_tr_b16 v[32:33], v5 offset:0
    ds_read_b64_tr_b16 v[34:35], v5 offset:2048
    ds_read_b128 v[40:43], v9 offset:16384
    v_mfma_f32_32x32x16_bf16 v[128:143], v[72:75], v[68:71], v[128:143]
    ds_read_b64_tr_b16 v[36:37], v5 offset:256
    ds_read_b64_tr_b16 v[38:39], v5 offset:2304
    ds_read_b128 v[44:47], v9 offset:20480
    v_mfma_f32_32x32x16_bf16 v[144:159], v[76:79], v[68:71], v[144:159]
    v_mfma_f32_32x32x16_bf16 v[96:111], v[88:91], v[80:83], v[96:111]
    ds_read_b64_tr_b16 v[48:49], v5 offset:4096
    ds_read_b64_tr_b16 v[50:51], v5 offset:6144
    v_mfma_f32_32x32x16_bf16 v[112:127], v[92:95], v[80:83], v[112:127]
    ds_read_b128 v[56:59], v9 offset:17408
    ds_read_b64_tr_b16 v[52:53], v5 offset:4352
    v_mfma_f32_32x32x16_bf16 v[128:143], v[88:91], v[84:87], v[128:143]
    ds_read_b64_tr_b16 v[54:55], v5 offset:6400
    ds_read_b128 v[60:63], v9 offset:21504
    v_mfma_f32_32x32x16_bf16 v[144:159], v[92:95], v[84:87], v[144:159]
    s_waitcnt lgkmcnt(6)
    v_mfma_f32_32x32x16_bf16 v[96:111], v[40:43], v[32:35], v[96:111]
    ds_read_b64_tr_b16 v[64:65], v5 offset:8192
    ds_read_b64_tr_b16 v[66:67], v5 offset:10240
    v_mfma_f32_32x32x16_bf16 v[112:127], v[44:47], v[32:35], v[112:127]
    ds_read_b128 v[72:75], v9 offset:18432
    ds_read_b64_tr_b16 v[68:69], v5 offset:8448
    v_mfma_f32_32x32x16_bf16 v[128:143], v[40:43], v[36:39], v[128:143]
    ds_read_b64_tr_b16 v[70:71], v5 offset:10496
    ds_read_b128 v[76:79], v9 offset:22528
    v_mfma_f32_32x32x16_bf16 v[144:159], v[44:47], v[36:39], v[144:159]
    s_waitcnt lgkmcnt(6)
    v_mfma_f32_32x32x16_bf16 v[96:111], v[56:59], v[48:51], v[96:111]
    ds_read_b64_tr_b16 v[80:81], v5 offset:12288
    ds_read_b64_tr_b16 v[82:83], v5 offset:14336
    v_mfma_f32_32x32x16_bf16 v[112:127], v[60:63], v[48:51], v[112:127]
    ds_read_b128 v[88:91], v9 offset:19456
    ds_read_b64_tr_b16 v[84:85], v5 offset:12544
    v_mfma_f32_32x32x16_bf16 v[128:143], v[56:59], v[52:55], v[128:143]
    ds_read_b64_tr_b16 v[86:87], v5 offset:14592
    ds_read_b128 v[92:95], v9 offset:23552
    v_mfma_f32_32x32x16_bf16 v[144:159], v[60:63], v[52:55], v[144:159]
    s_waitcnt lgkmcnt(0)
    v_mfma_f32_32x32x16_bf16 v[96:111], v[72:75], v[64:67], v[96:111]
    v_mfma_f32_32x32x16_bf16 v[112:127], v[76:79], v[64:67], v[112:127]
    s_barrier
    ds_read_b64_tr_b16 v[32:33], v5 offset:16384
    ds_read_b64_tr_b16 v[34:35], v5 offset:18432
    ds_read_b128 v[40:43], v9 offset:32768
    v_mfma_f32_32x32x16_bf16 v[128:143], v[72:75], v[68:71], v[128:143]
    ds_read_b64_tr_b16 v[36:37], v5 offset:16640
    ds_read_b64_tr_b16 v[38:39], v5 offset:18688
    ds_read_b128 v[44:47], v9 offset:36864
    v_mfma_f32_32x32x16_bf16 v[144:159], v[76:79], v[68:71], v[144:159]
    v_mfma_f32_32x32x16_bf16 v[96:111], v[88:91], v[80:83], v[96:111]
    ds_read_b64_tr_b16 v[48:49], v5 offset:20480
    ds_read_b64_tr_b16 v[50:51], v5 offset:22528
    v_mfma_f32_32x32x16_bf16 v[112:127], v[92:95], v[80:83], v[112:127]
    ds_read_b128 v[56:59], v9 offset:33792
    ds_read_b64_tr_b16 v[52:53], v5 offset:20736
    v_mfma_f32_32x32x16_bf16 v[128:143], v[88:91], v[84:87], v[128:143]
    ds_read_b64_tr_b16 v[54:55], v5 offset:22784
    ds_read_b128 v[60:63], v9 offset:37888
    v_mfma_f32_32x32x16_bf16 v[144:159], v[92:95], v[84:87], v[144:159]
    s_waitcnt lgkmcnt(6)
    v_mfma_f32_32x32x16_bf16 v[96:111], v[40:43], v[32:35], v[96:111]
    ds_read_b64_tr_b16 v[64:65], v5 offset:24576
    ds_read_b64_tr_b16 v[66:67], v5 offset:26624
    v_mfma_f32_32x32x16_bf16 v[112:127], v[44:47], v[32:35], v[112:127]
    ds_read_b128 v[72:75], v9 offset:34816
    ds_read_b64_tr_b16 v[68:69], v5 offset:24832
    v_mfma_f32_32x32x16_bf16 v[128:143], v[40:43], v[36:39], v[128:143]
    ds_read_b64_tr_b16 v[70:71], v5 offset:26880
    ds_read_b128 v[76:79], v9 offset:38912
    v_mfma_f32_32x32x16_bf16 v[144:159], v[44:47], v[36:39], v[144:159]
    s_waitcnt lgkmcnt(6)
    v_mfma_f32_32x32x16_bf16 v[96:111], v[56:59], v[48:51], v[96:111]
    ds_read_b64_tr_b16 v[80:81], v5 offset:28672
    ds_read_b64_tr_b16 v[82:83], v5 offset:30720
    v_mfma_f32_32x32x16_bf16 v[112:127], v[60:63], v[48:51], v[112:127]
    ds_read_b128 v[88:91], v9 offset:35840
    ds_read_b64_tr_b16 v[84:85], v5 offset:28928
    v_mfma_f32_32x32x16_bf16 v[128:143], v[56:59], v[52:55], v[128:143]
    ds_read_b64_tr_b16 v[86:87], v5 offset:30976
    ds_read_b128 v[92:95], v9 offset:39936
    v_mfma_f32_32x32x16_bf16 v[144:159], v[60:63], v[52:55], v[144:159]
    s_waitcnt lgkmcnt(0)
    v_mfma_f32_32x32x16_bf16 v[96:111], v[72:75], v[64:67], v[96:111]
    v_mfma_f32_32x32x16_bf16 v[112:127], v[76:79], v[64:67], v[112:127]
    s_barrier
    ds_read_b64_tr_b16 v[32:33], v10 offset:0
    ds_read_b64_tr_b16 v[34:35], v10 offset:2048
    ds_read_b128 v[40:43], v9 offset:0
    v_mfma_f32_32x32x16_bf16 v[128:143], v[72:75], v[68:71], v[128:143]
    ds_read_b64_tr_b16 v[36:37], v10 offset:256
    ds_read_b64_tr_b16 v[38:39], v10 offset:2304
    ds_read_b128 v[44:47], v9 offset:4096
    v_mfma_f32_32x32x16_bf16 v[144:159], v[76:79], v[68:71], v[144:159]
    v_mfma_f32_32x32x16_bf16 v[96:111], v[88:91], v[80:83], v[96:111]
    ds_read_b64_tr_b16 v[48:49], v10 offset:4096
    ds_read_b64_tr_b16 v[50:51], v10 offset:6144
    v_mfma_f32_32x32x16_bf16 v[112:127], v[92:95], v[80:83], v[112:127]
    ds_read_b128 v[56:59], v9 offset:1024
    ds_read_b64_tr_b16 v[52:53], v10 offset:4352
    v_mfma_f32_32x32x16_bf16 v[128:143], v[88:91], v[84:87], v[128:143]
    ds_read_b64_tr_b16 v[54:55], v10 offset:6400
    ds_read_b128 v[60:63], v9 offset:5120
    v_mfma_f32_32x32x16_bf16 v[144:159], v[92:95], v[84:87], v[144:159]
    s_waitcnt lgkmcnt(6)
    v_mfma_f32_32x32x16_bf16 v[96:111], v[40:43], v[32:35], v[96:111]
    ds_read_b64_tr_b16 v[64:65], v10 offset:8192
    ds_read_b64_tr_b16 v[66:67], v10 offset:10240
    v_mfma_f32_32x32x16_bf16 v[112:127], v[44:47], v[32:35], v[112:127]
    ds_read_b128 v[72:75], v9 offset:2048
    ds_read_b64_tr_b16 v[68:69], v10 offset:8448
    v_mfma_f32_32x32x16_bf16 v[128:143], v[40:43], v[36:39], v[128:143]
    ds_read_b64_tr_b16 v[70:71], v10 offset:10496
    ds_read_b128 v[76:79], v9 offset:6144
    v_mfma_f32_32x32x16_bf16 v[144:159], v[44:47], v[36:39], v[144:159]
    s_waitcnt lgkmcnt(6)
    v_mfma_f32_32x32x16_bf16 v[96:111], v[56:59], v[48:51], v[96:111]
    ds_read_b64_tr_b16 v[80:81], v10 offset:12288
    ds_read_b64_tr_b16 v[82:83], v10 offset:14336
    v_mfma_f32_32x32x16_bf16 v[112:127], v[60:63], v[48:51], v[112:127]
    ds_read_b128 v[88:91], v9 offset:3072
    ds_read_b64_tr_b16 v[84:85], v10 offset:12544
    v_mfma_f32_32x32x16_bf16 v[128:143], v[56:59], v[52:55], v[128:143]
    ds_read_b64_tr_b16 v[86:87], v10 offset:14592
    ds_read_b128 v[92:95], v9 offset:7168
    v_mfma_f32_32x32x16_bf16 v[144:159], v[60:63], v[52:55], v[144:159]
    s_waitcnt lgkmcnt(0)
    v_mfma_f32_32x32x16_bf16 v[96:111], v[72:75], v[64:67], v[96:111]
    v_mfma_f32_32x32x16_bf16 v[112:127], v[76:79], v[64:67], v[112:127]
    s_barrier
    ds_read_b64_tr_b16 v[32:33], v10 offset:16384
    ds_read_b64_tr_b16 v[34:35], v10 offset:18432
    ds_read_b128 v[40:43], v9 offset:16384
    v_mfma_f32_32x32x16_bf16 v[128:143], v[72:75], v[68:71], v[128:143]
    ds_read_b64_tr_b16 v[36:37], v10 offset:16640
    ds_read_b64_tr_b16 v[38:39], v10 offset:18688
    ds_read_b128 v[44:47], v9 offset:20480
    v_mfma_f32_32x32x16_bf16 v[144:159], v[76:79], v[68:71], v[144:159]
    v_mfma_f32_32x32x16_bf16 v[96:111], v[88:91], v[80:83], v[96:111]
    ds_read_b64_tr_b16 v[48:49], v10 offset:20480
    ds_read_b64_tr_b16 v[50:51], v10 offset:22528
    v_mfma_f32_32x32x16_bf16 v[112:127], v[92:95], v[80:83], v[112:127]
    ds_read_b128 v[56:59], v9 offset:17408
    ds_read_b64_tr_b16 v[52:53], v10 offset:20736
    v_mfma_f32_32x32x16_bf16 v[128:143], v[88:91], v[84:87], v[128:143]
    ds_read_b64_tr_b16 v[54:55], v10 offset:22784
    ds_read_b128 v[60:63], v9 offset:21504
    v_mfma_f32_32x32x16_bf16 v[144:159], v[92:95], v[84:87], v[144:159]
    s_waitcnt lgkmcnt(6)
    v_mfma_f32_32x32x16_bf16 v[96:111], v[40:43], v[32:35], v[96:111]
    ds_read_b64_tr_b16 v[64:65], v10 offset:24576
    ds_read_b64_tr_b16 v[66:67], v10 offset:26624
    v_mfma_f32_32x32x16_bf16 v[112:127], v[44:47], v[32:35], v[112:127]
    ds_read_b128 v[72:75], v9 offset:18432
    ds_read_b64_tr_b16 v[68:69], v10 offset:24832
    v_mfma_f32_32x32x16_bf16 v[128:143], v[40:43], v[36:39], v[128:143]
    ds_read_b64_tr_b16 v[70:71], v10 offset:26880
    ds_read_b128 v[76:79], v9 offset:22528
    v_mfma_f32_32x32x16_bf16 v[144:159], v[44:47], v[36:39], v[144:159]
    s_waitcnt lgkmcnt(6)
    v_mfma_f32_32x32x16_bf16 v[96:111], v[56:59], v[48:51], v[96:111]
    ds_read_b64_tr_b16 v[80:81], v10 offset:28672
    ds_read_b64_tr_b16 v[82:83], v10 offset:30720
    v_mfma_f32_32x32x16_bf16 v[112:127], v[60:63], v[48:51], v[112:127]
    ds_read_b128 v[88:91], v9 offset:19456
    ds_read_b64_tr_b16 v[84:85], v10 offset:28928
    v_mfma_f32_32x32x16_bf16 v[128:143], v[56:59], v[52:55], v[128:143]
    ds_read_b64_tr_b16 v[86:87], v10 offset:30976
    ds_read_b128 v[92:95], v9 offset:23552
    v_mfma_f32_32x32x16_bf16 v[144:159], v[60:63], v[52:55], v[144:159]
    s_waitcnt lgkmcnt(0)
    v_mfma_f32_32x32x16_bf16 v[96:111], v[72:75], v[64:67], v[96:111]
    v_mfma_f32_32x32x16_bf16 v[112:127], v[76:79], v[64:67], v[112:127]
    s_barrier
    ds_read_b64_tr_b16 v[32:33], v10 offset:32768
    ds_read_b64_tr_b16 v[34:35], v10 offset:34816
    ds_read_b128 v[40:43], v9 offset:32768
    v_mfma_f32_32x32x16_bf16 v[128:143], v[72:75], v[68:71], v[128:143]
    ds_read_b64_tr_b16 v[36:37], v10 offset:33024
    ds_read_b64_tr_b16 v[38:39], v10 offset:35072
    ds_read_b128 v[44:47], v9 offset:36864
    v_mfma_f32_32x32x16_bf16 v[144:159], v[76:79], v[68:71], v[144:159]
    v_mfma_f32_32x32x16_bf16 v[96:111], v[88:91], v[80:83], v[96:111]
    ds_read_b64_tr_b16 v[48:49], v10 offset:36864
    ds_read_b64_tr_b16 v[50:51], v10 offset:38912
    v_mfma_f32_32x32x16_bf16 v[112:127], v[92:95], v[80:83], v[112:127]
    ds_read_b128 v[56:59], v9 offset:33792
    ds_read_b64_tr_b16 v[52:53], v10 offset:37120
    v_mfma_f32_32x32x16_bf16 v[128:143], v[88:91], v[84:87], v[128:143]
    ds_read_b64_tr_b16 v[54:55], v10 offset:39168
    ds_read_b128 v[60:63], v9 offset:37888
    v_mfma_f32_32x32x16_bf16 v[144:159], v[92:95], v[84:87], v[144:159]
    s_waitcnt lgkmcnt(6)
    v_mfma_f32_32x32x16_bf16 v[96:111], v[40:43], v[32:35], v[96:111]
    ds_read_b64_tr_b16 v[64:65], v10 offset:40960
    ds_read_b64_tr_b16 v[66:67], v10 offset:43008
    v_mfma_f32_32x32x16_bf16 v[112:127], v[44:47], v[32:35], v[112:127]
    ds_read_b128 v[72:75], v9 offset:34816
    ds_read_b64_tr_b16 v[68:69], v10 offset:41216
    v_mfma_f32_32x32x16_bf16 v[128:143], v[40:43], v[36:39], v[128:143]
    ds_read_b64_tr_b16 v[70:71], v10 offset:43264
    ds_read_b128 v[76:79], v9 offset:38912
    v_mfma_f32_32x32x16_bf16 v[144:159], v[44:47], v[36:39], v[144:159]
    s_waitcnt lgkmcnt(6)
    v_mfma_f32_32x32x16_bf16 v[96:111], v[56:59], v[48:51], v[96:111]
    ds_read_b64_tr_b16 v[80:81], v10 offset:45056
    ds_read_b64_tr_b16 v[82:83], v10 offset:47104
    v_mfma_f32_32x32x16_bf16 v[112:127], v[60:63], v[48:51], v[112:127]
    ds_read_b128 v[88:91], v9 offset:35840
    ds_read_b64_tr_b16 v[84:85], v10 offset:45312
    v_mfma_f32_32x32x16_bf16 v[128:143], v[56:59], v[52:55], v[128:143]
    ds_read_b64_tr_b16 v[86:87], v10 offset:47360
    ds_read_b128 v[92:95], v9 offset:39936
    v_mfma_f32_32x32x16_bf16 v[144:159], v[60:63], v[52:55], v[144:159]
    s_waitcnt lgkmcnt(0)
    v_mfma_f32_32x32x16_bf16 v[96:111], v[72:75], v[64:67], v[96:111]
    v_mfma_f32_32x32x16_bf16 v[112:127], v[76:79], v[64:67], v[112:127]
    s_barrier
    ds_read_b64_tr_b16 v[32:33], v10 offset:49152
    ds_read_b64_tr_b16 v[34:35], v10 offset:51200
    ds_read_b128 v[40:43], v9 offset:0
    v_mfma_f32_32x32x16_bf16 v[128:143], v[72:75], v[68:71], v[128:143]
    ds_read_b64_tr_b16 v[36:37], v10 offset:49408
    ds_read_b64_tr_b16 v[38:39], v10 offset:51456
    ds_read_b128 v[44:47], v9 offset:4096
    v_mfma_f32_32x32x16_bf16 v[144:159], v[76:79], v[68:71], v[144:159]
    v_mfma_f32_32x32x16_bf16 v[96:111], v[88:91], v[80:83], v[96:111]
    ds_read_b64_tr_b16 v[48:49], v10 offset:53248
    ds_read_b64_tr_b16 v[50:51], v10 offset:55296
    v_mfma_f32_32x32x16_bf16 v[112:127], v[92:95], v[80:83], v[112:127]
    ds_read_b128 v[56:59], v9 offset:1024
    ds_read_b64_tr_b16 v[52:53], v10 offset:53504
    v_mfma_f32_32x32x16_bf16 v[128:143], v[88:91], v[84:87], v[128:143]
    ds_read_b64_tr_b16 v[54:55], v10 offset:55552
    ds_read_b128 v[60:63], v9 offset:5120
    v_mfma_f32_32x32x16_bf16 v[144:159], v[92:95], v[84:87], v[144:159]
    s_waitcnt lgkmcnt(6)
    v_mfma_f32_32x32x16_bf16 v[96:111], v[40:43], v[32:35], v[96:111]
    ds_read_b64_tr_b16 v[64:65], v10 offset:57344
    ds_read_b64_tr_b16 v[66:67], v10 offset:59392
    s_lshl_b32 s41, s44, 6
    v_add_u32 v11, s41, v3
    v_mfma_f32_32x32x16_bf16 v[112:127], v[44:47], v[32:35], v[112:127]
    ds_read_b128 v[72:75], v9 offset:2048
    ds_read_b64_tr_b16 v[68:69], v10 offset:57600
    v_lshlrev_b32 v12, 2, v11
    v_add_u32 v12, 147456, v12
    v_mfma_f32_32x32x16_bf16 v[128:143], v[40:43], v[36:39], v[128:143]
    ds_read_b64_tr_b16 v[70:71], v10 offset:59648
    ds_read_b128 v[76:79], v9 offset:6144
    ds_read_b32 v224, v12
    ds_read_b32 v226, v12 offset:128
    v_mfma_f32_32x32x16_bf16 v[144:159], v[44:47], v[36:39], v[144:159]
    s_lshl_b32 s42, s45, 8
    s_add_u32 s42, s42, 147968
    s_waitcnt lgkmcnt(6)
    v_mfma_f32_32x32x16_bf16 v[96:111], v[56:59], v[48:51], v[96:111]
    ds_read_b64_tr_b16 v[80:81], v10 offset:61440
    ds_read_b64_tr_b16 v[82:83], v10 offset:63488
    v_lshlrev_b32 v11, 4, v2
    v_add_u32 v11, s42, v11
    v_mfma_f32_32x32x16_bf16 v[112:127], v[60:63], v[48:51], v[112:127]
    ds_read_b128 v[88:91], v9 offset:3072
    ds_read_b64_tr_b16 v[84:85], v10 offset:61696
    ds_read_b128 v[160:163], v11 offset:0
    ds_read_b128 v[176:179], v11 offset:512
    v_mfma_f32_32x32x16_bf16 v[128:143], v[56:59], v[52:55], v[128:143]
    ds_read_b64_tr_b16 v[86:87], v10 offset:63744
    ds_read_b128 v[92:95], v9 offset:7168
    ds_read_b128 v[164:167], v11 offset:32
    ds_read_b128 v[180:183], v11 offset:544
    v_mfma_f32_32x32x16_bf16 v[144:159], v[60:63], v[52:55], v[144:159]
    ds_read_b128 v[168:171], v11 offset:64
    ds_read_b128 v[184:187], v11 offset:576
    s_waitcnt lgkmcnt(0)
    v_mfma_f32_32x32x16_bf16 v[96:111], v[72:75], v[64:67], v[96:111]
    ds_read_b128 v[172:175], v11 offset:96
    ds_read_b128 v[188:191], v11 offset:608
    v_mfma_f32_32x32x16_bf16 v[112:127], v[76:79], v[64:67], v[112:127]
    s_barrier
    ds_read_b128 v[192:195], v11 offset:128
    ds_read_b128 v[208:211], v11 offset:640
    v_mfma_f32_32x32x16_bf16 v[128:143], v[72:75], v[68:71], v[128:143]
    ds_read_b128 v[196:199], v11 offset:160
    ds_read_b128 v[212:215], v11 offset:672
    v_mfma_f32_32x32x16_bf16 v[144:159], v[76:79], v[68:71], v[144:159]
    ds_read_b128 v[200:203], v11 offset:192
    ds_read_b128 v[216:219], v11 offset:704
    v_mfma_f32_32x32x16_bf16 v[96:111], v[88:91], v[80:83], v[96:111]
    ds_read_b128 v[204:207], v11 offset:224
    ds_read_b128 v[220:223], v11 offset:736
    v_mfma_f32_32x32x16_bf16 v[112:127], v[92:95], v[80:83], v[112:127]
    v_mfma_f32_32x32x16_bf16 v[128:143], v[88:91], v[84:87], v[128:143]
    v_mfma_f32_32x32x16_bf16 v[144:159], v[92:95], v[84:87], v[144:159]
    s_lshl_b32 s41, s29, 2
    s_lshl_b32 s42, s45, 1
    s_add_u32 s41, s41, s42
    s_mul_i32 s41, s41, 1408
    s_waitcnt lgkmcnt(0)
    v_sub_f32 v224, 0, v224
    v_sub_f32 v226, 0, v226
    v_mov_b32 v225, v224
    v_mov_b32 v227, v226
    v_pk_mul_f32 v[96:97], v[96:97], v[160:161]
    v_pk_mul_f32 v[98:99], v[98:99], v[162:163]
    v_pk_mul_f32 v[100:101], v[100:101], v[164:165]
    v_pk_mul_f32 v[102:103], v[102:103], v[166:167]
    v_pk_mul_f32 v[104:105], v[104:105], v[168:169]
    v_pk_mul_f32 v[106:107], v[106:107], v[170:171]
    v_pk_mul_f32 v[108:109], v[108:109], v[172:173]
    v_pk_mul_f32 v[110:111], v[110:111], v[174:175]
    v_pk_fma_f32 v[96:97], v[176:177], v[224:225], v[96:97]
    v_pk_fma_f32 v[98:99], v[178:179], v[224:225], v[98:99]
    v_pk_fma_f32 v[100:101], v[180:181], v[224:225], v[100:101]
    v_pk_fma_f32 v[102:103], v[182:183], v[224:225], v[102:103]
    v_pk_fma_f32 v[104:105], v[184:185], v[224:225], v[104:105]
    v_pk_fma_f32 v[106:107], v[186:187], v[224:225], v[106:107]
    v_pk_fma_f32 v[108:109], v[188:189], v[224:225], v[108:109]
    v_pk_fma_f32 v[110:111], v[190:191], v[224:225], v[110:111]
    v_cvt_pk_bf16_f32 v32, v96, v97
    v_cvt_pk_bf16_f32 v33, v98, v99
    v_cvt_pk_bf16_f32 v34, v100, v101
    v_cvt_pk_bf16_f32 v35, v102, v103
    v_cvt_pk_bf16_f32 v36, v104, v105
    v_cvt_pk_bf16_f32 v37, v106, v107
    v_cvt_pk_bf16_f32 v38, v108, v109
    v_cvt_pk_bf16_f32 v39, v110, v111
    buffer_store_dwordx4 v[32:35], v228, s[24:27], s41 offen sc1
    buffer_store_dwordx4 v[36:39], v228, s[24:27], s41 offen offset:704 sc1
    v_pk_mul_f32 v[128:129], v[128:129], v[160:161]
    v_pk_mul_f32 v[130:131], v[130:131], v[162:163]
    v_pk_mul_f32 v[132:133], v[132:133], v[164:165]
    v_pk_mul_f32 v[134:135], v[134:135], v[166:167]
    v_pk_mul_f32 v[136:137], v[136:137], v[168:169]
    v_pk_mul_f32 v[138:139], v[138:139], v[170:171]
    v_pk_mul_f32 v[140:141], v[140:141], v[172:173]
    v_pk_mul_f32 v[142:143], v[142:143], v[174:175]
    v_pk_fma_f32 v[128:129], v[176:177], v[226:227], v[128:129]
    v_pk_fma_f32 v[130:131], v[178:179], v[226:227], v[130:131]
    v_pk_fma_f32 v[132:133], v[180:181], v[226:227], v[132:133]
    v_pk_fma_f32 v[134:135], v[182:183], v[226:227], v[134:135]
    v_pk_fma_f32 v[136:137], v[184:185], v[226:227], v[136:137]
    v_pk_fma_f32 v[138:139], v[186:187], v[226:227], v[138:139]
    v_pk_fma_f32 v[140:141], v[188:189], v[226:227], v[140:141]
    v_pk_fma_f32 v[142:143], v[190:191], v[226:227], v[142:143]
    v_cvt_pk_bf16_f32 v40, v128, v129
    v_cvt_pk_bf16_f32 v41, v130, v131
    v_cvt_pk_bf16_f32 v42, v132, v133
    v_cvt_pk_bf16_f32 v43, v134, v135
    v_cvt_pk_bf16_f32 v44, v136, v137
    v_cvt_pk_bf16_f32 v45, v138, v139
    v_cvt_pk_bf16_f32 v46, v140, v141
    v_cvt_pk_bf16_f32 v47, v142, v143
    buffer_store_dwordx4 v[40:43], v229, s[24:27], s41 offen sc1
    buffer_store_dwordx4 v[44:47], v229, s[24:27], s41 offen offset:704 sc1
    v_pk_mul_f32 v[112:113], v[112:113], v[192:193]
    v_pk_mul_f32 v[114:115], v[114:115], v[194:195]
    v_pk_mul_f32 v[116:117], v[116:117], v[196:197]
    v_pk_mul_f32 v[118:119], v[118:119], v[198:199]
    v_pk_mul_f32 v[120:121], v[120:121], v[200:201]
    v_pk_mul_f32 v[122:123], v[122:123], v[202:203]
    v_pk_mul_f32 v[124:125], v[124:125], v[204:205]
    v_pk_mul_f32 v[126:127], v[126:127], v[206:207]
    v_pk_fma_f32 v[112:113], v[208:209], v[224:225], v[112:113]
    v_pk_fma_f32 v[114:115], v[210:211], v[224:225], v[114:115]
    v_pk_fma_f32 v[116:117], v[212:213], v[224:225], v[116:117]
    v_pk_fma_f32 v[118:119], v[214:215], v[224:225], v[118:119]
    v_pk_fma_f32 v[120:121], v[216:217], v[224:225], v[120:121]
    v_pk_fma_f32 v[122:123], v[218:219], v[224:225], v[122:123]
    v_pk_fma_f32 v[124:125], v[220:221], v[224:225], v[124:125]
    v_pk_fma_f32 v[126:127], v[222:223], v[224:225], v[126:127]
    v_cvt_pk_bf16_f32 v48, v112, v113
    v_cvt_pk_bf16_f32 v49, v114, v115
    v_cvt_pk_bf16_f32 v50, v116, v117
    v_cvt_pk_bf16_f32 v51, v118, v119
    v_cvt_pk_bf16_f32 v52, v120, v121
    v_cvt_pk_bf16_f32 v53, v122, v123
    v_cvt_pk_bf16_f32 v54, v124, v125
    v_cvt_pk_bf16_f32 v55, v126, v127
    buffer_store_dwordx4 v[48:51], v228, s[24:27], s41 offen offset:1408 sc1
    buffer_store_dwordx4 v[52:55], v228, s[24:27], s41 offen offset:2112 sc1
    v_pk_mul_f32 v[144:145], v[144:145], v[192:193]
    v_pk_mul_f32 v[146:147], v[146:147], v[194:195]
    v_pk_mul_f32 v[148:149], v[148:149], v[196:197]
    v_pk_mul_f32 v[150:151], v[150:151], v[198:199]
    v_pk_mul_f32 v[152:153], v[152:153], v[200:201]
    v_pk_mul_f32 v[154:155], v[154:155], v[202:203]
    v_pk_mul_f32 v[156:157], v[156:157], v[204:205]
    v_pk_mul_f32 v[158:159], v[158:159], v[206:207]
    v_pk_fma_f32 v[144:145], v[208:209], v[226:227], v[144:145]
    v_pk_fma_f32 v[146:147], v[210:211], v[226:227], v[146:147]
    v_pk_fma_f32 v[148:149], v[212:213], v[226:227], v[148:149]
    v_pk_fma_f32 v[150:151], v[214:215], v[226:227], v[150:151]
    v_pk_fma_f32 v[152:153], v[216:217], v[226:227], v[152:153]
    v_pk_fma_f32 v[154:155], v[218:219], v[226:227], v[154:155]
    v_pk_fma_f32 v[156:157], v[220:221], v[226:227], v[156:157]
    v_pk_fma_f32 v[158:159], v[222:223], v[226:227], v[158:159]
    v_cvt_pk_bf16_f32 v56, v144, v145
    v_cvt_pk_bf16_f32 v57, v146, v147
    v_cvt_pk_bf16_f32 v58, v148, v149
    v_cvt_pk_bf16_f32 v59, v150, v151
    v_cvt_pk_bf16_f32 v60, v152, v153
    v_cvt_pk_bf16_f32 v61, v154, v155
    v_cvt_pk_bf16_f32 v62, v156, v157
    v_cvt_pk_bf16_f32 v63, v158, v159
    buffer_store_dwordx4 v[56:59], v229, s[24:27], s41 offen offset:1408 sc1
    buffer_store_dwordx4 v[60:63], v229, s[24:27], s41 offen offset:2112 sc1
L_cw_fin:
    s_waitcnt vmcnt(0)
    s_barrier
    s_cmp_lg_u32 s3, 0
    s_cbranch_scc1 L_fl_15
    v_mov_b32 v248, s6
    buffer_store_dword v248, v252, s[96:99], 0 offen sc0 sc1
L_fl_15:
    s_cmp_eq_u32 s31, 3
    s_cbranch_scc1 C_FB
    s_branch C_ATT
C_ATT:
    s_and_b32 s24, s2, 31
    s_lshr_b32 s25, s2, 5
    s_cmp_lg_u32 s3, 0
    s_cbranch_scc1 L_w0_16
    s_lshl_b32 s46, s25, 5
    v_mov_b32 v12, v1
    v_add_u32 v12, s46, v12
    v_mov_b32 v13, s24
    v_cmp_gt_u32 vcc, 32, v1
    s_mov_b32 s47, s7
    s_mul_i32 s47, s47, 0x100000
    s_add_u32 s47, s47, 0x20000
    v_lshlrev_b32 v12, 9, v12
    v_lshl_add_u32 v252, v13, 4, v12
    v_add_u32 v252, s47, v252
    v_mov_b32 v12, s101
    v_cndmask_b32 v252, v12, v252, vcc
    s_mul_i32 s46, s24, 20
    s_lshr_b32 s40, s46, 7
    s_add_u32 s46, s46, 19
    s_lshr_b32 s41, s46, 7
    s_cmp_lg_u32 s40, s41
    s_cselect_b64 s[92:93], -1, 0
    v_lshlrev_b32 v244, 4, v1
    v_bfe_u32 v12, v1, 4, 1
    v_cmp_eq_u32 vcc, 0, v12
    s_nop 1
    s_or_b64 vcc, vcc, s[92:93]
    v_mov_b32 v12, s101
    v_mov_b32 v245, s6
    v_cndmask_b32 v244, v12, v244, vcc
    v_cndmask_b32 v245, 0, v245, vcc
    v_lshlrev_b32 v246, 4, v1
    v_add_u32 v246, 1024, v246
    v_cmp_gt_u32 vcc, 2, v1
    v_cmp_gt_u32 s[48:49], 4, v1
    s_nop 1
    s_and_b64 s[48:49], s[48:49], s[92:93]
    s_or_b64 vcc, vcc, s[48:49]
    v_mov_b32 v247, s6
    v_cndmask_b32 v246, v12, v246, vcc
    v_cndmask_b32 v247, 0, v247, vcc
    s_mov_b32 s94, s7
    s_mul_i32 s94, s94, 0x100000
    s_add_u32 s94, s94, 0x80000
    s_lshl_b32 s46, s2, 11
    s_add_u32 s94, s94, s46
L_w0_16:
    s_and_b32 s27, s3, 1
    s_lshr_b32 s28, s3, 1
    s_and_b32 s34, s24, 1
    s_mul_i32 s32, s34, 1536
    v_lshlrev_b32 v4, 4, v1
    v_add_u32 v4, s32, v4
    s_lshl_b32 s32, s34, 3
    s_add_u32 s32, s32, 1024
    v_lshlrev_b32 v5, 4, v3
    v_add_u32 v5, s32, v5
    v_min_u32 v11, 20, v3
    v_cmp_lt_u32 vcc, 20, v3
    v_mul_u32_u24 v6, 22, v2
    s_nop 0
    v_addc_co_u32 v11, vcc, 0, v11, vcc
    v_add_u32 v6, v6, v11
    v_lshlrev_b32 v6, 4, v6
    s_lshl_b32 s32, s28, 5
    s_mul_i32 s36, s32, 2560
    s_mul_i32 s38, s32, 1408
    s_lshl_b32 s37, s25, 3
    s_lshl_b32 s34, s27, 2
    s_add_u32 s37, s37, s34
    s_mov_b32 s42, -1
    s_mov_b32 s43, 0
    s_mov_b32 s35, 0
    s_mul_i32 s34, s7, 0x1400000
    s_lshr_b32 s32, s24, 1
    s_mul_i32 s32, s32, 163840
    s_add_u32 s32, s32, s34
    s_add_u32 s33, s32, 0x1280000
    s_add_u32 s12, s4, s33
    s_addc_u32 s13, s5, 0
    s_mov_b32 s14, 163840
    s_mov_b32 s15, 0x20000
    s_add_u32 s33, s32, 0x1000000
    s_add_u32 s8, s4, s33
    s_addc_u32 s9, s5, 0
    s_mov_b32 s10, 163840
    s_mov_b32 s11, 0x20000
    s_mul_i32 s32, s24, 90112
    s_add_u32 s32, s32, s34
    s_add_u32 s33, s32, 0x1500000
    s_add_u32 s16, s4, s33
    s_addc_u32 s17, s5, 0
    s_mov_b32 s18, 90112
    s_mov_b32 s19, 0x20000
    s_add_u32 s33, s34, 0x1800000
    s_add_u32 s20, s4, s33
    s_addc_u32 s21, s5, 0
    s_mov_b32 s22, 2621440
    s_mov_b32 s23, 0x20000
    v_mov_b32 v20, 0
    v_mov_b32 v21, 0
    v_mov_b32 v22, 0
    v_mov_b32 v23, 0
    v_mov_b32 v28, 0
    v_mov_b32 v29, 0
    v_mov_b32 v30, 0
    v_mov_b32 v31, 0
    v_mov_b32 v36, 0
    v_mov_b32 v37, 0
    v_mov_b32 v38, 0
    v_mov_b32 v39, 0
    v_mov_b32 v44, 0
    v_mov_b32 v45, 0
    v_mov_b32 v46, 0
    v_mov_b32 v47, 0
    v_mov_b32 v158, 0x3f803f80
    v_mov_b32 v159, 0x00003f80
    v_mov_b32 v166, 0x3f803f80
    v_mov_b32 v167, 0x00003f80
    v_mov_b32 v144, 0
    v_mov_b32 v145, 0
    v_mov_b32 v146, 0
    v_mov_b32 v147, 0
    v_mov_b32 v148, 0
    v_mov_b32 v149, 0
    v_mov_b32 v150, 0
    v_mov_b32 v151, 0
    v_mov_b32 v180, 0
    v_mov_b32 v181, 0
    v_mov_b32 v182, 0
    v_mov_b32 v183, 0
    v_mov_b32 v48, 0
    v_mov_b32 v49, 0
    v_mov_b32 v50, 0
    v_mov_b32 v51, 0
    v_mov_b32 v52, 0
    v_mov_b32 v53, 0
    v_mov_b32 v54, 0
    v_mov_b32 v55, 0
    v_mov_b32 v56, 0
    v_mov_b32 v57, 0
    v_mov_b32 v58, 0
    v_mov_b32 v59, 0
    v_mov_b32 v60, 0
    v_mov_b32 v61, 0
    v_mov_b32 v62, 0
    v_mov_b32 v63, 0
    v_mov_b32 v64, 0
    v_mov_b32 v65, 0
    v_mov_b32 v66, 0
    v_mov_b32 v67, 0
    v_mov_b32 v68, 0
    v_mov_b32 v69, 0
    v_mov_b32 v70, 0
    v_mov_b32 v71, 0
    v_mov_b32 v72, 0
    v_mov_b32 v73, 0
    v_mov_b32 v74, 0
    v_mov_b32 v75, 0
    v_mov_b32 v76, 0
    v_mov_b32 v77, 0
    v_mov_b32 v78, 0
    v_mov_b32 v79, 0
    v_mov_b32 v80, 0
    v_mov_b32 v81, 0
    v_mov_b32 v82, 0
    v_mov_b32 v83, 0
    v_mov_b32 v84, 0
    v_mov_b32 v85, 0
    v_mov_b32 v86, 0
    v_mov_b32 v87, 0
    v_mov_b32 v88, 0
    v_mov_b32 v89, 0
    v_mov_b32 v90, 0
    v_mov_b32 v91, 0
    v_mov_b32 v92, 0
    v_mov_b32 v93, 0
    v_mov_b32 v94, 0
    v_mov_b32 v95, 0
    v_mov_b32 v96, 0
    v_mov_b32 v97, 0
    v_mov_b32 v98, 0
    v_mov_b32 v99, 0
    v_mov_b32 v100, 0
    v_mov_b32 v101, 0
    v_mov_b32 v102, 0
    v_mov_b32 v103, 0
    v_mov_b32 v104, 0
    v_mov_b32 v105, 0
    v_mov_b32 v106, 0
    v_mov_b32 v107, 0
    v_mov_b32 v108, 0
    v_mov_b32 v109, 0
    v_mov_b32 v110, 0
    v_mov_b32 v111, 0
    s_mul_i32 s32, s24, 5
    v_add_u32 v15, s32, v2
    v_lshlrev_b32 v12, 4, v3
    v_add_u32 v13, 0, v15
    v_lshrrev_b32 v14, 2, v13
    v_lshl_add_u32 v7, v14, 10, v12
    v_and_b32 v14, 1, v13
    v_lshl_add_u32 v7, v14, 9, v7
    v_bfe_u32 v14, v13, 1, 1
    v_lshl_add_u32 v7, v14, 3, v7
    v_add_u32 v13, 2, v15
    v_lshrrev_b32 v14, 2, v13
    v_lshl_add_u32 v8, v14, 10, v12
    v_and_b32 v14, 1, v13
    v_lshl_add_u32 v8, v14, 9, v8
    v_bfe_u32 v14, v13, 1, 1
    v_lshl_add_u32 v8, v14, 3, v8
    v_add_u32 v13, 4, v15
    v_lshrrev_b32 v14, 2, v13
    v_lshl_add_u32 v9, v14, 10, v12
    v_and_b32 v14, 1, v13
    v_lshl_add_u32 v9, v14, 9, v9
    v_bfe_u32 v14, v13, 1, 1
    v_lshl_add_u32 v9, v14, 3, v9
    s_mul_i32 s32, s37, 2560
    s_add_u32 s33, s32, 5120
    s_mov_b32 s29, s36
    s_mov_b32 s30, s38
    s_cmp_lg_u32 s3, 0
    s_cbranch_scc1 L_polld_18
    s_mov_b32 s95, 0x10000
    buffer_load_dword v248, v244, s[96:99], s94 offen sc0 sc1
    buffer_load_dword v249, v246, s[96:99], s94 offen sc0 sc1
L_poll_17:
    s_waitcnt vmcnt(0)
    v_cmp_eq_u32 vcc, v248, v245
    v_cmp_eq_u32 s[92:93], v249, v247
    s_nop 1
    s_and_b64 vcc, vcc, s[92:93]
    s_cmp_eq_u64 vcc, exec
    s_cbranch_scc1 L_polld_18
    buffer_load_dword v248, v244, s[96:99], s94 offen sc0 sc1
    buffer_load_dword v249, v246, s[96:99], s94 offen sc0 sc1
    s_sub_u32 s95, s95, 1
    s_cmp_lg_u32 s95, 0
    s_cbranch_scc1 L_poll_17
L_polld_18:
    s_barrier
    buffer_load_dwordx4 v[152:155], v4, s[12:15], s29 offen
    buffer_load_dwordx2 v[156:157], v5, s[12:15], s29 offen
    buffer_load_dwordx4 v[16:19], v4, s[8:11], s32 offen
    buffer_load_dwordx4 v[24:27], v4, s[8:11], s32 offen offset:2560
    buffer_load_dwordx4 v[32:35], v4, s[8:11], s33 offen
    buffer_load_dwordx4 v[40:43], v4, s[8:11], s33 offen offset:2560
    s_mov_b64 exec, s[42:43]
    buffer_load_dwordx2 v[20:21], v5, s[8:11], s32 offen
    buffer_load_dwordx2 v[28:29], v5, s[8:11], s32 offen offset:2560
    buffer_load_dwordx2 v[36:37], v5, s[8:11], s33 offen
    buffer_load_dwordx2 v[44:45], v5, s[8:11], s33 offen offset:2560
    s_mov_b64 exec, -1
    buffer_load_dwordx4 v[168:171], v6, s[16:19], s30 offen
    buffer_load_dwordx4 v[172:175], v6, s[16:19], s30 offen offset:704
    buffer_load_dwordx4 v[160:163], v4, s[12:15], s29 offen offset:2560
    buffer_load_dwordx2 v[164:165], v5, s[12:15], s29 offen offset:2560
    s_add_u32 s29, s36, 5120
    s_add_u32 s30, s38, 1408
    s_waitcnt vmcnt(4)
    v_mfma_f32_32x32x16_bf16 v[112:127], v[152:155], v[16:19], 0
    v_mfma_f32_32x32x16_bf16 v[112:127], v[156:159], v[20:23], v[112:127]
    v_mfma_f32_32x32x16_bf16 v[128:143], v[152:155], v[24:27], 0
    v_mfma_f32_32x32x16_bf16 v[128:143], v[156:159], v[28:31], v[128:143]
    v_mfma_f32_32x32x16_bf16 v[200:215], v[152:155], v[32:35], 0
    v_mfma_f32_32x32x16_bf16 v[200:215], v[156:159], v[36:39], v[200:215]
    v_mfma_f32_32x32x16_bf16 v[216:231], v[152:155], v[40:43], 0
    v_mfma_f32_32x32x16_bf16 v[216:231], v[156:159], v[44:47], v[216:231]
    s_nop 5
    v_max3_f32 v184, v112, v113, v114
    v_max3_f32 v184, v184, v115, v116
    v_max3_f32 v184, v184, v117, v118
    v_max3_f32 v184, v184, v119, v120
    v_max3_f32 v184, v184, v121, v122
    v_max3_f32 v184, v184, v123, v124
    v_max3_f32 v184, v184, v125, v126
    v_max_f32 v184, v184, v127
    v_mov_b32 v188, v184
    s_nop 1
    v_permlane32_swap_b32 v184, v188
    v_max_f32 v184, v184, v188
    v_max3_f32 v185, v128, v129, v130
    v_max3_f32 v185, v185, v131, v132
    v_max3_f32 v185, v185, v133, v134
    v_max3_f32 v185, v185, v135, v136
    v_max3_f32 v185, v185, v137, v138
    v_max3_f32 v185, v185, v139, v140
    v_max3_f32 v185, v185, v141, v142
    v_max_f32 v185, v185, v143
    v_mov_b32 v189, v185
    s_nop 1
    v_permlane32_swap_b32 v185, v189
    v_max_f32 v185, v185, v189
    v_max3_f32 v186, v200, v201, v202
    v_max3_f32 v186, v186, v203, v204
    v_max3_f32 v186, v186, v205, v206
    v_max3_f32 v186, v186, v207, v208
    v_max3_f32 v186, v186, v209, v210
    v_max3_f32 v186, v186, v211, v212
    v_max3_f32 v186, v186, v213, v214
    v_max_f32 v186, v186, v215
    v_mov_b32 v190, v186
    s_nop 1
    v_permlane32_swap_b32 v186, v190
    v_max_f32 v186, v186, v190
    v_max3_f32 v187, v216, v217, v218
    v_max3_f32 v187, v187, v219, v220
    v_max3_f32 v187, v187, v221, v222
    v_max3_f32 v187, v187, v223, v224
    v_max3_f32 v187, v187, v225, v226
    v_max3_f32 v187, v187, v227, v228
    v_max3_f32 v187, v187, v229, v230
    v_max_f32 v187, v187, v231
    v_mov_b32 v191, v187
    s_nop 1
    v_permlane32_swap_b32 v187, v191
    v_max_f32 v187, v187, v191
    s_mov_b64 exec, s[42:43]
    v_xor_b32 v10, 0x80000000, v184
    v_and_b32 v11, 0xffff0000, v10
    v_sub_f32 v10, v10, v11
    v_and_b32 v12, 0xffff0000, v10
    v_sub_f32 v10, v10, v12
    v_lshrrev_b32 v11, 16, v11
    v_or_b32 v22, v11, v12
    v_lshrrev_b32 v23, 16, v10
    v_xor_b32 v10, 0x80000000, v185
    v_and_b32 v11, 0xffff0000, v10
    v_sub_f32 v10, v10, v11
    v_and_b32 v12, 0xffff0000, v10
    v_sub_f32 v10, v10, v12
    v_lshrrev_b32 v11, 16, v11
    v_or_b32 v30, v11, v12
    v_lshrrev_b32 v31, 16, v10
    v_xor_b32 v10, 0x80000000, v186
    v_and_b32 v11, 0xffff0000, v10
    v_sub_f32 v10, v10, v11
    v_and_b32 v12, 0xffff0000, v10
    v_sub_f32 v10, v10, v12
    v_lshrrev_b32 v11, 16, v11
    v_or_b32 v38, v11, v12
    v_lshrrev_b32 v39, 16, v10
    v_xor_b32 v10, 0x80000000, v187
    v_and_b32 v11, 0xffff0000, v10
    v_sub_f32 v10, v10, v11
    v_and_b32 v12, 0xffff0000, v10
    v_sub_f32 v10, v10, v12
    v_lshrrev_b32 v11, 16, v11
    v_or_b32 v46, v11, v12
    v_lshrrev_b32 v47, 16, v10
    s_mov_b64 exec, -1
L_ca_setup:
    v_mfma_f32_32x32x16_bf16 v[112:127], v[152:155], v[16:19], 0
    v_mfma_f32_32x32x16_bf16 v[112:127], v[156:159], v[20:23], v[112:127]
    s_mov_b32 s31, 16
    s_nop 7
.p2align 6
L_ca_loop:
    v_mfma_f32_32x32x16_bf16 v[128:143], v[152:155], v[24:27], 0
    s_nop 1
    v_exp_f32 v112, v112
    v_exp_f32 v113, v113
    v_exp_f32 v114, v114
    v_exp_f32 v115, v115
    v_cvt_pk_bf16_f32 v144, v112, v113
    v_mfma_f32_32x32x16_bf16 v[128:143], v[156:159], v[28:31], v[128:143]
    v_exp_f32 v116, v116
    v_exp_f32 v117, v117
    v_cvt_pk_bf16_f32 v145, v114, v115
    v_exp_f32 v118, v118
    v_exp_f32 v119, v119
    v_cvt_pk_bf16_f32 v146, v116, v117
    v_mfma_f32_32x32x16_bf16 v[96:111], v[180:183], v[148:151], v[96:111]
    v_exp_f32 v120, v120
    v_exp_f32 v121, v121
    v_cvt_pk_bf16_f32 v147, v118, v119
    v_exp_f32 v122, v122
    v_exp_f32 v123, v123
    v_cvt_pk_bf16_f32 v148, v120, v121
    s_waitcnt vmcnt(2)
    v_mfma_f32_32x32x16_bf16 v[48:63], v[168:171], v[144:147], v[48:63]
    v_exp_f32 v124, v124
    v_exp_f32 v125, v125
    v_cvt_pk_bf16_f32 v149, v122, v123
    v_exp_f32 v126, v126
    v_exp_f32 v127, v127
    v_cvt_pk_bf16_f32 v150, v124, v125
    v_cvt_pk_bf16_f32 v151, v126, v127
    v_mfma_f32_32x32x16_bf16 v[112:127], v[152:155], v[32:35], 0
    v_exp_f32 v128, v128
    v_exp_f32 v129, v129
    v_exp_f32 v130, v130
    v_exp_f32 v131, v131
    v_cvt_pk_bf16_f32 v144, v128, v129
    v_mfma_f32_32x32x16_bf16 v[112:127], v[156:159], v[36:39], v[112:127]
    v_exp_f32 v132, v132
    v_exp_f32 v133, v133
    v_cvt_pk_bf16_f32 v145, v130, v131
    buffer_load_dwordx4 v[176:179], v6, s[16:19], s30 offen
    buffer_load_dwordx4 v[180:183], v6, s[16:19], s30 offen offset:704
    v_exp_f32 v134, v134
    v_exp_f32 v135, v135
    v_cvt_pk_bf16_f32 v146, v132, v133
    v_mfma_f32_32x32x16_bf16 v[48:63], v[172:175], v[148:151], v[48:63]
    v_exp_f32 v136, v136
    v_exp_f32 v137, v137
    v_cvt_pk_bf16_f32 v147, v134, v135
    v_exp_f32 v138, v138
    v_exp_f32 v139, v139
    v_cvt_pk_bf16_f32 v148, v136, v137
    v_mfma_f32_32x32x16_bf16 v[64:79], v[168:171], v[144:147], v[64:79]
    v_exp_f32 v140, v140
    v_exp_f32 v141, v141
    v_cvt_pk_bf16_f32 v149, v138, v139
    v_exp_f32 v142, v142
    v_exp_f32 v143, v143
    v_cvt_pk_bf16_f32 v150, v140, v141
    v_cvt_pk_bf16_f32 v151, v142, v143
    v_mfma_f32_32x32x16_bf16 v[128:143], v[152:155], v[40:43], 0
    v_exp_f32 v112, v112
    v_exp_f32 v113, v113
    v_exp_f32 v114, v114
    v_exp_f32 v115, v115
    v_cvt_pk_bf16_f32 v144, v112, v113
    v_mfma_f32_32x32x16_bf16 v[128:143], v[156:159], v[44:47], v[128:143]
    v_exp_f32 v116, v116
    v_exp_f32 v117, v117
    v_cvt_pk_bf16_f32 v145, v114, v115
    v_exp_f32 v118, v118
    v_exp_f32 v119, v119
    v_cvt_pk_bf16_f32 v146, v116, v117
    v_mfma_f32_32x32x16_bf16 v[64:79], v[172:175], v[148:151], v[64:79]
    v_exp_f32 v120, v120
    v_exp_f32 v121, v121
    v_cvt_pk_bf16_f32 v147, v118, v119
    v_exp_f32 v122, v122
    v_exp_f32 v123, v123
    v_cvt_pk_bf16_f32 v148, v120, v121
    v_mfma_f32_32x32x16_bf16 v[80:95], v[168:171], v[144:147], v[80:95]
    v_exp_f32 v124, v124
    v_exp_f32 v125, v125
    v_cvt_pk_bf16_f32 v149, v122, v123
    v_exp_f32 v126, v126
    v_exp_f32 v127, v127
    v_cvt_pk_bf16_f32 v150, v124, v125
    v_cvt_pk_bf16_f32 v151, v126, v127
    s_waitcnt vmcnt(2)
    v_mfma_f32_32x32x16_bf16 v[112:127], v[160:163], v[16:19], 0
    v_exp_f32 v128, v128
    v_exp_f32 v129, v129
    v_exp_f32 v130, v130
    v_exp_f32 v131, v131
    v_cvt_pk_bf16_f32 v144, v128, v129
    v_mfma_f32_32x32x16_bf16 v[112:127], v[164:167], v[20:23], v[112:127]
    v_exp_f32 v132, v132
    v_exp_f32 v133, v133
    v_cvt_pk_bf16_f32 v145, v130, v131
    buffer_load_dwordx4 v[152:155], v4, s[12:15], s29 offen
    buffer_load_dwordx2 v[156:157], v5, s[12:15], s29 offen
    v_exp_f32 v134, v134
    v_exp_f32 v135, v135
    v_cvt_pk_bf16_f32 v146, v132, v133
    v_mfma_f32_32x32x16_bf16 v[80:95], v[172:175], v[148:151], v[80:95]
    v_exp_f32 v136, v136
    v_exp_f32 v137, v137
    v_cvt_pk_bf16_f32 v147, v134, v135
    v_exp_f32 v138, v138
    v_exp_f32 v139, v139
    v_cvt_pk_bf16_f32 v148, v136, v137
    v_mfma_f32_32x32x16_bf16 v[96:111], v[168:171], v[144:147], v[96:111]
    v_exp_f32 v140, v140
    v_exp_f32 v141, v141
    v_cvt_pk_bf16_f32 v149, v138, v139
    v_exp_f32 v142, v142
    v_exp_f32 v143, v143
    v_cvt_pk_bf16_f32 v150, v140, v141
    v_cvt_pk_bf16_f32 v151, v142, v143
    v_mfma_f32_32x32x16_bf16 v[128:143], v[160:163], v[24:27], 0
    v_exp_f32 v112, v112
    v_exp_f32 v113, v113
    v_exp_f32 v114, v114
    v_exp_f32 v115, v115
    v_cvt_pk_bf16_f32 v144, v112, v113
    v_mfma_f32_32x32x16_bf16 v[128:143], v[164:167], v[28:31], v[128:143]
    v_exp_f32 v116, v116
    v_exp_f32 v117, v117
    v_cvt_pk_bf16_f32 v145, v114, v115
    v_exp_f32 v118, v118
    v_exp_f32 v119, v119
    v_cvt_pk_bf16_f32 v146, v116, v117
    v_mfma_f32_32x32x16_bf16 v[96:111], v[172:175], v[148:151], v[96:111]
    v_exp_f32 v120, v120
    v_exp_f32 v121, v121
    v_cvt_pk_bf16_f32 v147, v118, v119
    v_exp_f32 v122, v122
    v_exp_f32 v123, v123
    v_cvt_pk_bf16_f32 v148, v120, v121
    s_waitcnt vmcnt(2)
    v_mfma_f32_32x32x16_bf16 v[48:63], v[176:179], v[144:147], v[48:63]
    v_exp_f32 v124, v124
    v_exp_f32 v125, v125
    v_cvt_pk_bf16_f32 v149, v122, v123
    v_exp_f32 v126, v126
    v_exp_f32 v127, v127
    v_cvt_pk_bf16_f32 v150, v124, v125
    v_cvt_pk_bf16_f32 v151, v126, v127
    v_mfma_f32_32x32x16_bf16 v[112:127], v[160:163], v[32:35], 0
    v_exp_f32 v128, v128
    v_exp_f32 v129, v129
    v_exp_f32 v130, v130
    v_exp_f32 v131, v131
    v_cvt_pk_bf16_f32 v144, v128, v129
    v_mfma_f32_32x32x16_bf16 v[112:127], v[164:167], v[36:39], v[112:127]
    v_exp_f32 v132, v132
    v_exp_f32 v133, v133
    v_cvt_pk_bf16_f32 v145, v130, v131
    buffer_load_dwordx4 v[168:171], v6, s[16:19], s30 offen offset:1408
    buffer_load_dwordx4 v[172:175], v6, s[16:19], s30 offen offset:2112
    v_exp_f32 v134, v134
    v_exp_f32 v135, v135
    v_cvt_pk_bf16_f32 v146, v132, v133
    v_mfma_f32_32x32x16_bf16 v[48:63], v[180:183], v[148:151], v[48:63]
    v_exp_f32 v136, v136
    v_exp_f32 v137, v137
    v_cvt_pk_bf16_f32 v147, v134, v135
    v_exp_f32 v138, v138
    v_exp_f32 v139, v139
    v_cvt_pk_bf16_f32 v148, v136, v137
    v_mfma_f32_32x32x16_bf16 v[64:79], v[176:179], v[144:147], v[64:79]
    v_exp_f32 v140, v140
    v_exp_f32 v141, v141
    v_cvt_pk_bf16_f32 v149, v138, v139
    v_exp_f32 v142, v142
    v_exp_f32 v143, v143
    v_cvt_pk_bf16_f32 v150, v140, v141
    v_cvt_pk_bf16_f32 v151, v142, v143
    v_mfma_f32_32x32x16_bf16 v[128:143], v[160:163], v[40:43], 0
    v_exp_f32 v112, v112
    v_exp_f32 v113, v113
    v_exp_f32 v114, v114
    v_exp_f32 v115, v115
    v_cvt_pk_bf16_f32 v144, v112, v113
    v_mfma_f32_32x32x16_bf16 v[128:143], v[164:167], v[44:47], v[128:143]
    v_exp_f32 v116, v116
    v_exp_f32 v117, v117
    v_cvt_pk_bf16_f32 v145, v114, v115
    v_exp_f32 v118, v118
    v_exp_f32 v119, v119
    v_cvt_pk_bf16_f32 v146, v116, v117
    v_mfma_f32_32x32x16_bf16 v[64:79], v[180:183], v[148:151], v[64:79]
    v_exp_f32 v120, v120
    v_exp_f32 v121, v121
    v_cvt_pk_bf16_f32 v147, v118, v119
    v_exp_f32 v122, v122
    v_exp_f32 v123, v123
    v_cvt_pk_bf16_f32 v148, v120, v121
    v_mfma_f32_32x32x16_bf16 v[80:95], v[176:179], v[144:147], v[80:95]
    v_exp_f32 v124, v124
    v_exp_f32 v125, v125
    v_cvt_pk_bf16_f32 v149, v122, v123
    v_exp_f32 v126, v126
    v_exp_f32 v127, v127
    v_cvt_pk_bf16_f32 v150, v124, v125
    v_cvt_pk_bf16_f32 v151, v126, v127
    s_waitcnt vmcnt(2)
    v_mfma_f32_32x32x16_bf16 v[112:127], v[152:155], v[16:19], 0
    v_exp_f32 v128, v128
    v_exp_f32 v129, v129
    v_exp_f32 v130, v130
    v_exp_f32 v131, v131
    v_cvt_pk_bf16_f32 v144, v128, v129
    v_mfma_f32_32x32x16_bf16 v[112:127], v[156:159], v[20:23], v[112:127]
    v_exp_f32 v132, v132
    v_exp_f32 v133, v133
    v_cvt_pk_bf16_f32 v145, v130, v131
    buffer_load_dwordx4 v[160:163], v4, s[12:15], s29 offen offset:2560
    buffer_load_dwordx2 v[164:165], v5, s[12:15], s29 offen offset:2560
    v_exp_f32 v134, v134
    v_exp_f32 v135, v135
    v_cvt_pk_bf16_f32 v146, v132, v133
    v_mfma_f32_32x32x16_bf16 v[80:95], v[180:183], v[148:151], v[80:95]
    v_exp_f32 v136, v136
    v_exp_f32 v137, v137
    v_cvt_pk_bf16_f32 v147, v134, v135
    v_exp_f32 v138, v138
    v_exp_f32 v139, v139
    v_cvt_pk_bf16_f32 v148, v136, v137
    v_mfma_f32_32x32x16_bf16 v[96:111], v[176:179], v[144:147], v[96:111]
    v_exp_f32 v140, v140
    v_exp_f32 v141, v141
    v_cvt_pk_bf16_f32 v149, v138, v139
    v_exp_f32 v142, v142
    v_exp_f32 v143, v143
    v_cvt_pk_bf16_f32 v150, v140, v141
    v_cvt_pk_bf16_f32 v151, v142, v143
    s_add_u32 s29, s29, 5120
    s_add_u32 s30, s30, 2816
    s_sub_u32 s31, s31, 1
    s_cmp_lg_u32 s31, 0
    s_cbranch_scc1 L_ca_loop
    v_mfma_f32_32x32x16_bf16 v[96:111], v[180:183], v[148:151], v[96:111]
    s_waitcnt vmcnt(0)
    v_mov_b32 v60, v56
    v_mov_b32 v61, v56
    v_mov_b32 v76, v72
    v_mov_b32 v77, v72
    v_mov_b32 v92, v88
    v_mov_b32 v93, v88
    s_nop 4
    v_mov_b32 v108, v104
    v_mov_b32 v109, v104
    v_permlane32_swap_b32 v61, v60
    v_permlane32_swap_b32 v77, v76
    v_permlane32_swap_b32 v93, v92
    v_permlane32_swap_b32 v109, v108
    s_cmp_lg_u32 s35, 0
    s_cbranch_scc1 L_ca_combine
    v_mov_b32 v10, 0
    v_max3_f32 v10, v10, |v48|, |v49|
    v_max3_f32 v10, v10, |v50|, |v51|
    v_max3_f32 v10, v10, |v52|, |v53|
    v_max3_f32 v10, v10, |v54|, |v55|
    v_max3_f32 v10, v10, |v56|, |v57|
    v_max3_f32 v10, v10, |v58|, |v59|
    v_max3_f32 v10, v10, |v64|, |v65|
    v_max3_f32 v10, v10, |v66|, |v67|
    v_max3_f32 v10, v10, |v68|, |v69|
    v_max3_f32 v10, v10, |v70|, |v71|
    v_max3_f32 v10, v10, |v72|, |v73|
    v_max3_f32 v10, v10, |v74|, |v75|
    v_max3_f32 v10, v10, |v80|, |v81|
    v_max3_f32 v10, v10, |v82|, |v83|
    v_max3_f32 v10, v10, |v84|, |v85|
    v_max3_f32 v10, v10, |v86|, |v87|
    v_max3_f32 v10, v10, |v88|, |v89|
    v_max3_f32 v10, v10, |v90|, |v91|
    v_max3_f32 v10, v10, |v96|, |v97|
    v_max3_f32 v10, v10, |v98|, |v99|
    v_max3_f32 v10, v10, |v100|, |v101|
    v_max3_f32 v10, v10, |v102|, |v103|
    v_max3_f32 v10, v10, |v104|, |v105|
    v_max3_f32 v10, v10, |v106|, |v107|
    v_add_f32 v12, v60, v76
    v_add_f32 v13, v92, v108
    v_add_f32 v12, v12, v13
    s_mov_b32 s32, 0x53800000
    s_mov_b32 s33, 0x7b800000
    v_cmp_gt_f32 vcc, s32, v12
    v_cmp_gt_f32 s[44:45], s33, v10
    s_nop 1
    s_and_b64 vcc, vcc, s[44:45]
    s_cmp_eq_u64 vcc, exec
    s_cbranch_scc1 L_ca_combine
    s_mov_b32 s35, 1
    s_mov_b64 exec, s[42:43]
    v_mov_b32 v22, 0
    v_mov_b32 v23, 0
    v_mov_b32 v30, 0
    v_mov_b32 v31, 0
    v_mov_b32 v38, 0
    v_mov_b32 v39, 0
    v_mov_b32 v46, 0
    v_mov_b32 v47, 0
    s_mov_b64 exec, -1
    v_mov_b32 v192, 0xff800000
    v_mov_b32 v193, 0xff800000
    v_mov_b32 v194, 0xff800000
    v_mov_b32 v195, 0xff800000
    s_mov_b32 s29, s36
    s_mov_b32 s31, 32
L_ca_tm_loop:
    buffer_load_dwordx4 v[152:155], v4, s[12:15], s29 offen
    buffer_load_dwordx2 v[156:157], v5, s[12:15], s29 offen
    s_add_u32 s29, s29, 2560
    s_waitcnt vmcnt(0)
    v_mfma_f32_32x32x16_bf16 v[48:63], v[152:155], v[16:19], 0
    v_mfma_f32_32x32x16_bf16 v[48:63], v[156:159], v[20:23], v[48:63]
    v_mfma_f32_32x32x16_bf16 v[64:79], v[152:155], v[24:27], 0
    v_mfma_f32_32x32x16_bf16 v[64:79], v[156:159], v[28:31], v[64:79]
    v_mfma_f32_32x32x16_bf16 v[80:95], v[152:155], v[32:35], 0
    v_mfma_f32_32x32x16_bf16 v[80:95], v[156:159], v[36:39], v[80:95]
    v_mfma_f32_32x32x16_bf16 v[96:111], v[152:155], v[40:43], 0
    v_mfma_f32_32x32x16_bf16 v[96:111], v[156:159], v[44:47], v[96:111]
    s_nop 5
    v_max3_f32 v184, v48, v49, v50
    v_max3_f32 v184, v184, v51, v52
    v_max3_f32 v184, v184, v53, v54
    v_max3_f32 v184, v184, v55, v56
    v_max3_f32 v184, v184, v57, v58
    v_max3_f32 v184, v184, v59, v60
    v_max3_f32 v184, v184, v61, v62
    v_max_f32 v184, v184, v63
    v_mov_b32 v188, v184
    s_nop 1
    v_permlane32_swap_b32 v184, v188
    v_max_f32 v184, v184, v188
    v_max_f32 v192, v192, v184
    v_max3_f32 v185, v64, v65, v66
    v_max3_f32 v185, v185, v67, v68
    v_max3_f32 v185, v185, v69, v70
    v_max3_f32 v185, v185, v71, v72
    v_max3_f32 v185, v185, v73, v74
    v_max3_f32 v185, v185, v75, v76
    v_max3_f32 v185, v185, v77, v78
    v_max_f32 v185, v185, v79
    v_mov_b32 v189, v185
    s_nop 1
    v_permlane32_swap_b32 v185, v189
    v_max_f32 v185, v185, v189
    v_max_f32 v193, v193, v185
    v_max3_f32 v186, v80, v81, v82
    v_max3_f32 v186, v186, v83, v84
    v_max3_f32 v186, v186, v85, v86
    v_max3_f32 v186, v186, v87, v88
    v_max3_f32 v186, v186, v89, v90
    v_max3_f32 v186, v186, v91, v92
    v_max3_f32 v186, v186, v93, v94
    v_max_f32 v186, v186, v95
    v_mov_b32 v190, v186
    s_nop 1
    v_permlane32_swap_b32 v186, v190
    v_max_f32 v186, v186, v190
    v_max_f32 v194, v194, v186
    v_max3_f32 v187, v96, v97, v98
    v_max3_f32 v187, v187, v99, v100
    v_max3_f32 v187, v187, v101, v102
    v_max3_f32 v187, v187, v103, v104
    v_max3_f32 v187, v187, v105, v106
    v_max3_f32 v187, v187, v107, v108
    v_max3_f32 v187, v187, v109, v110
    v_max_f32 v187, v187, v111
    v_mov_b32 v191, v187
    s_nop 1
    v_permlane32_swap_b32 v187, v191
    v_max_f32 v187, v187, v191
    v_max_f32 v195, v195, v187
    s_sub_u32 s31, s31, 1
    s_cmp_lg_u32 s31, 0
    s_cbranch_scc1 L_ca_tm_loop
    v_mov_b32 v184, v192
    v_mov_b32 v185, v193
    v_mov_b32 v186, v194
    v_mov_b32 v187, v195
    s_mov_b32 s29, s36
    s_mov_b32 s30, s38
    buffer_load_dwordx4 v[152:155], v4, s[12:15], s29 offen
    buffer_load_dwordx2 v[156:157], v5, s[12:15], s29 offen
    buffer_load_dwordx4 v[168:171], v6, s[16:19], s30 offen
    buffer_load_dwordx4 v[172:175], v6, s[16:19], s30 offen offset:704
    buffer_load_dwordx4 v[160:163], v4, s[12:15], s29 offen offset:2560
    buffer_load_dwordx2 v[164:165], v5, s[12:15], s29 offen offset:2560
    s_add_u32 s29, s36, 5120
    s_add_u32 s30, s38, 1408
    s_mov_b64 exec, s[42:43]
    v_xor_b32 v10, 0x80000000, v184
    v_and_b32 v11, 0xffff0000, v10
    v_sub_f32 v10, v10, v11
    v_and_b32 v12, 0xffff0000, v10
    v_sub_f32 v10, v10, v12
    v_lshrrev_b32 v11, 16, v11
    v_or_b32 v22, v11, v12
    v_lshrrev_b32 v23, 16, v10
    v_xor_b32 v10, 0x80000000, v185
    v_and_b32 v11, 0xffff0000, v10
    v_sub_f32 v10, v10, v11
    v_and_b32 v12, 0xffff0000, v10
    v_sub_f32 v10, v10, v12
    v_lshrrev_b32 v11, 16, v11
    v_or_b32 v30, v11, v12
    v_lshrrev_b32 v31, 16, v10
    v_xor_b32 v10, 0x80000000, v186
    v_and_b32 v11, 0xffff0000, v10
    v_sub_f32 v10, v10, v11
    v_and_b32 v12, 0xffff0000, v10
    v_sub_f32 v10, v10, v12
    v_lshrrev_b32 v11, 16, v11
    v_or_b32 v38, v11, v12
    v_lshrrev_b32 v39, 16, v10
    v_xor_b32 v10, 0x80000000, v187
    v_and_b32 v11, 0xffff0000, v10
    v_sub_f32 v10, v10, v11
    v_and_b32 v12, 0xffff0000, v10
    v_sub_f32 v10, v10, v12
    v_lshrrev_b32 v11, 16, v11
    v_or_b32 v46, v11, v12
    v_lshrrev_b32 v47, 16, v10
    s_mov_b64 exec, -1
    v_mov_b32 v48, 0
    v_mov_b32 v49, 0
    v_mov_b32 v50, 0
    v_mov_b32 v51, 0
    v_mov_b32 v52, 0
    v_mov_b32 v53, 0
    v_mov_b32 v54, 0
    v_mov_b32 v55, 0
    v_mov_b32 v56, 0
    v_mov_b32 v57, 0
    v_mov_b32 v58, 0
    v_mov_b32 v59, 0
    v_mov_b32 v60, 0
    v_mov_b32 v61, 0
    v_mov_b32 v62, 0
    v_mov_b32 v63, 0
    v_mov_b32 v64, 0
    v_mov_b32 v65, 0
    v_mov_b32 v66, 0
    v_mov_b32 v67, 0
    v_mov_b32 v68, 0
    v_mov_b32 v69, 0
    v_mov_b32 v70, 0
    v_mov_b32 v71, 0
    v_mov_b32 v72, 0
    v_mov_b32 v73, 0
    v_mov_b32 v74, 0
    v_mov_b32 v75, 0
    v_mov_b32 v76, 0
    v_mov_b32 v77, 0
    v_mov_b32 v78, 0
    v_mov_b32 v79, 0
    v_mov_b32 v80, 0
    v_mov_b32 v81, 0
    v_mov_b32 v82, 0
    v_mov_b32 v83, 0
    v_mov_b32 v84, 0
    v_mov_b32 v85, 0
    v_mov_b32 v86, 0
    v_mov_b32 v87, 0
    v_mov_b32 v88, 0
    v_mov_b32 v89, 0
    v_mov_b32 v90, 0
    v_mov_b32 v91, 0
    v_mov_b32 v92, 0
    v_mov_b32 v93, 0
    v_mov_b32 v94, 0
    v_mov_b32 v95, 0
    v_mov_b32 v96, 0
    v_mov_b32 v97, 0
    v_mov_b32 v98, 0
    v_mov_b32 v99, 0
    v_mov_b32 v100, 0
    v_mov_b32 v101, 0
    v_mov_b32 v102, 0
    v_mov_b32 v103, 0
    v_mov_b32 v104, 0
    v_mov_b32 v105, 0
    v_mov_b32 v106, 0
    v_mov_b32 v107, 0
    v_mov_b32 v108, 0
    v_mov_b32 v109, 0
    v_mov_b32 v110, 0
    v_mov_b32 v111, 0
    v_mov_b32 v144, 0
    v_mov_b32 v145, 0
    v_mov_b32 v146, 0
    v_mov_b32 v147, 0
    v_mov_b32 v148, 0
    v_mov_b32 v149, 0
    v_mov_b32 v150, 0
    v_mov_b32 v151, 0
    v_mov_b32 v180, 0
    v_mov_b32 v181, 0
    v_mov_b32 v182, 0
    v_mov_b32 v183, 0
    v_mov_b32 v48, 0
    v_mov_b32 v49, 0
    v_mov_b32 v50, 0
    v_mov_b32 v51, 0
    v_mov_b32 v52, 0
    v_mov_b32 v53, 0
    v_mov_b32 v54, 0
    v_mov_b32 v55, 0
    v_mov_b32 v56, 0
    v_mov_b32 v57, 0
    v_mov_b32 v58, 0
    v_mov_b32 v59, 0
    v_mov_b32 v60, 0
    v_mov_b32 v61, 0
    v_mov_b32 v62, 0
    v_mov_b32 v63, 0
    v_mov_b32 v64, 0
    v_mov_b32 v65, 0
    v_mov_b32 v66, 0
    v_mov_b32 v67, 0
    v_mov_b32 v68, 0
    v_mov_b32 v69, 0
    v_mov_b32 v70, 0
    v_mov_b32 v71, 0
    v_mov_b32 v72, 0
    v_mov_b32 v73, 0
    v_mov_b32 v74, 0
    v_mov_b32 v75, 0
    v_mov_b32 v76, 0
    v_mov_b32 v77, 0
    v_mov_b32 v78, 0
    v_mov_b32 v79, 0
    v_mov_b32 v80, 0
    v_mov_b32 v81, 0
    v_mov_b32 v82, 0
    v_mov_b32 v83, 0
    v_mov_b32 v84, 0
    v_mov_b32 v85, 0
    v_mov_b32 v86, 0
    v_mov_b32 v87, 0
    v_mov_b32 v88, 0
    v_mov_b32 v89, 0
    v_mov_b32 v90, 0
    v_mov_b32 v91, 0
    v_mov_b32 v92, 0
    v_mov_b32 v93, 0
    v_mov_b32 v94, 0
    v_mov_b32 v95, 0
    v_mov_b32 v96, 0
    v_mov_b32 v97, 0
    v_mov_b32 v98, 0
    v_mov_b32 v99, 0
    v_mov_b32 v100, 0
    v_mov_b32 v101, 0
    v_mov_b32 v102, 0
    v_mov_b32 v103, 0
    v_mov_b32 v104, 0
    v_mov_b32 v105, 0
    v_mov_b32 v106, 0
    v_mov_b32 v107, 0
    v_mov_b32 v108, 0
    v_mov_b32 v109, 0
    v_mov_b32 v110, 0
    v_mov_b32 v111, 0
    s_mul_i32 s32, s24, 5
    v_add_u32 v15, s32, v2
    v_lshlrev_b32 v12, 4, v3
    v_add_u32 v13, 0, v15
    v_lshrrev_b32 v14, 2, v13
    v_lshl_add_u32 v7, v14, 10, v12
    v_and_b32 v14, 1, v13
    v_lshl_add_u32 v7, v14, 9, v7
    v_bfe_u32 v14, v13, 1, 1
    v_lshl_add_u32 v7, v14, 3, v7
    v_add_u32 v13, 2, v15
    v_lshrrev_b32 v14, 2, v13
    v_lshl_add_u32 v8, v14, 10, v12
    v_and_b32 v14, 1, v13
    v_lshl_add_u32 v8, v14, 9, v8
    v_bfe_u32 v14, v13, 1, 1
    v_lshl_add_u32 v8, v14, 3, v8
    v_add_u32 v13, 4, v15
    v_lshrrev_b32 v14, 2, v13
    v_lshl_add_u32 v9, v14, 10, v12
    v_and_b32 v14, 1, v13
    v_lshl_add_u32 v9, v14, 9, v9
    v_bfe_u32 v14, v13, 1, 1
    v_lshl_add_u32 v9, v14, 3, v9
    s_waitcnt vmcnt(4)
    s_branch L_ca_setup
L_ca_combine:
    v_mov_b32 v61, v184
    v_mov_b32 v77, v185
    v_mov_b32 v93, v186
    v_mov_b32 v109, v187
    s_lshl_b32 s32, s3, 13
    s_add_u32 s32, s32, 0
    v_lshlrev_b32 v10, 4, v1
    v_add_u32 v11, s32, v10
    s_xor_b32 s33, s3, 2
    s_lshl_b32 s33, s33, 13
    s_add_u32 s33, s33, 0
    v_add_u32 v12, s33, v10
    s_cmp_eq_u32 s28, 0
    s_cbranch_scc0 L_ca_c1
    ds_write_b128 v11, v[80:83] offset:0
    ds_write_b128 v11, v[84:87] offset:1024
    ds_write_b128 v11, v[88:91] offset:2048
    ds_write_b128 v11, v[92:95] offset:3072
    ds_write_b128 v11, v[96:99] offset:4096
    ds_write_b128 v11, v[100:103] offset:5120
    ds_write_b128 v11, v[104:107] offset:6144
    ds_write_b128 v11, v[108:111] offset:7168
    s_waitcnt lgkmcnt(0)
    s_barrier
    ds_read_b128 v[112:115], v12 offset:0
    ds_read_b128 v[116:119], v12 offset:1024
    ds_read_b128 v[120:123], v12 offset:2048
    ds_read_b128 v[124:127], v12 offset:3072
    ds_read_b128 v[128:131], v12 offset:4096
    ds_read_b128 v[132:135], v12 offset:5120
    ds_read_b128 v[136:139], v12 offset:6144
    ds_read_b128 v[140:143], v12 offset:7168
    s_waitcnt lgkmcnt(4)
    v_max_f32 v188, v61, v125
    v_sub_f32 v189, v61, v188
    v_sub_f32 v190, v125, v188
    v_exp_f32 v189, v189
    v_exp_f32 v190, v190
    s_nop 0
    v_mul_f32 v191, v189, v60
    v_fmac_f32 v191, v190, v124
    v_rcp_f32 v191, v191
    s_nop 0
    v_mul_f32 v192, v189, v191
    v_mul_f32 v194, v190, v191
    v_mov_b32 v193, v192
    v_mov_b32 v195, v194
    v_pk_mul_f32 v[48:49], v[48:49], v[192:193]
    v_pk_mul_f32 v[50:51], v[50:51], v[192:193]
    v_pk_mul_f32 v[52:53], v[52:53], v[192:193]
    v_pk_mul_f32 v[54:55], v[54:55], v[192:193]
    v_pk_mul_f32 v[56:57], v[56:57], v[192:193]
    v_pk_mul_f32 v[58:59], v[58:59], v[192:193]
    v_pk_fma_f32 v[48:49], v[112:113], v[194:195], v[48:49]
    v_pk_fma_f32 v[50:51], v[114:115], v[194:195], v[50:51]
    v_pk_fma_f32 v[52:53], v[116:117], v[194:195], v[52:53]
    v_pk_fma_f32 v[54:55], v[118:119], v[194:195], v[54:55]
    v_pk_fma_f32 v[56:57], v[120:121], v[194:195], v[56:57]
    v_pk_fma_f32 v[58:59], v[122:123], v[194:195], v[58:59]
    v_cvt_pk_bf16_f32 v144, v48, v49
    v_cvt_pk_bf16_f32 v145, v50, v51
    v_cvt_pk_bf16_f32 v146, v52, v53
    v_cvt_pk_bf16_f32 v147, v54, v55
    v_cvt_pk_bf16_f32 v148, v56, v57
    v_cvt_pk_bf16_f32 v149, v58, v59
    s_add_u32 s33, s37, 0
    s_mul_i32 s33, s33, 40960
    buffer_store_dwordx2 v[144:145], v7, s[20:23], s33 offen sc1
    buffer_store_dwordx2 v[146:147], v8, s[20:23], s33 offen sc1
    s_mov_b64 exec, s[42:43]
    buffer_store_dwordx2 v[148:149], v9, s[20:23], s33 offen sc1
    s_mov_b64 exec, -1
    s_waitcnt lgkmcnt(0)
    v_max_f32 v188, v77, v141
    v_sub_f32 v189, v77, v188
    v_sub_f32 v190, v141, v188
    v_exp_f32 v189, v189
    v_exp_f32 v190, v190
    s_nop 0
    v_mul_f32 v191, v189, v76
    v_fmac_f32 v191, v190, v140
    v_rcp_f32 v191, v191
    s_nop 0
    v_mul_f32 v192, v189, v191
    v_mul_f32 v194, v190, v191
    v_mov_b32 v193, v192
    v_mov_b32 v195, v194
    v_pk_mul_f32 v[64:65], v[64:65], v[192:193]
    v_pk_mul_f32 v[66:67], v[66:67], v[192:193]
    v_pk_mul_f32 v[68:69], v[68:69], v[192:193]
    v_pk_mul_f32 v[70:71], v[70:71], v[192:193]
    v_pk_mul_f32 v[72:73], v[72:73], v[192:193]
    v_pk_mul_f32 v[74:75], v[74:75], v[192:193]
    v_pk_fma_f32 v[64:65], v[128:129], v[194:195], v[64:65]
    v_pk_fma_f32 v[66:67], v[130:131], v[194:195], v[66:67]
    v_pk_fma_f32 v[68:69], v[132:133], v[194:195], v[68:69]
    v_pk_fma_f32 v[70:71], v[134:135], v[194:195], v[70:71]
    v_pk_fma_f32 v[72:73], v[136:137], v[194:195], v[72:73]
    v_pk_fma_f32 v[74:75], v[138:139], v[194:195], v[74:75]
    v_cvt_pk_bf16_f32 v152, v64, v65
    v_cvt_pk_bf16_f32 v153, v66, v67
    v_cvt_pk_bf16_f32 v154, v68, v69
    v_cvt_pk_bf16_f32 v155, v70, v71
    v_cvt_pk_bf16_f32 v156, v72, v73
    v_cvt_pk_bf16_f32 v157, v74, v75
    s_add_u32 s33, s37, 1
    s_mul_i32 s33, s33, 40960
    buffer_store_dwordx2 v[152:153], v7, s[20:23], s33 offen sc1
    buffer_store_dwordx2 v[154:155], v8, s[20:23], s33 offen sc1
    s_mov_b64 exec, s[42:43]
    buffer_store_dwordx2 v[156:157], v9, s[20:23], s33 offen sc1
    s_mov_b64 exec, -1
    s_branch L_ca_fin
L_ca_c1:
    ds_write_b128 v11, v[48:51] offset:0
    ds_write_b128 v11, v[52:55] offset:1024
    ds_write_b128 v11, v[56:59] offset:2048
    ds_write_b128 v11, v[60:63] offset:3072
    ds_write_b128 v11, v[64:67] offset:4096
    ds_write_b128 v11, v[68:71] offset:5120
    ds_write_b128 v11, v[72:75] offset:6144
    ds_write_b128 v11, v[76:79] offset:7168
    s_waitcnt lgkmcnt(0)
    s_barrier
    ds_read_b128 v[112:115], v12 offset:0
    ds_read_b128 v[116:119], v12 offset:1024
    ds_read_b128 v[120:123], v12 offset:2048
    ds_read_b128 v[124:127], v12 offset:3072
    ds_read_b128 v[128:131], v12 offset:4096
    ds_read_b128 v[132:135], v12 offset:5120
    ds_read_b128 v[136:139], v12 offset:6144
    ds_read_b128 v[140:143], v12 offset:7168
    s_waitcnt lgkmcnt(4)
    v_max_f32 v188, v93, v125
    v_sub_f32 v189, v93, v188
    v_sub_f32 v190, v125, v188
    v_exp_f32 v189, v189
    v_exp_f32 v190, v190
    s_nop 0
    v_mul_f32 v191, v189, v92
    v_fmac_f32 v191, v190, v124
    v_rcp_f32 v191, v191
    s_nop 0
    v_mul_f32 v192, v189, v191
    v_mul_f32 v194, v190, v191
    v_mov_b32 v193, v192
    v_mov_b32 v195, v194
    v_pk_mul_f32 v[80:81], v[80:81], v[192:193]
    v_pk_mul_f32 v[82:83], v[82:83], v[192:193]
    v_pk_mul_f32 v[84:85], v[84:85], v[192:193]
    v_pk_mul_f32 v[86:87], v[86:87], v[192:193]
    v_pk_mul_f32 v[88:89], v[88:89], v[192:193]
    v_pk_mul_f32 v[90:91], v[90:91], v[192:193]
    v_pk_fma_f32 v[80:81], v[112:113], v[194:195], v[80:81]
    v_pk_fma_f32 v[82:83], v[114:115], v[194:195], v[82:83]
    v_pk_fma_f32 v[84:85], v[116:117], v[194:195], v[84:85]
    v_pk_fma_f32 v[86:87], v[118:119], v[194:195], v[86:87]
    v_pk_fma_f32 v[88:89], v[120:121], v[194:195], v[88:89]
    v_pk_fma_f32 v[90:91], v[122:123], v[194:195], v[90:91]
    v_cvt_pk_bf16_f32 v144, v80, v81
    v_cvt_pk_bf16_f32 v145, v82, v83
    v_cvt_pk_bf16_f32 v146, v84, v85
    v_cvt_pk_bf16_f32 v147, v86, v87
    v_cvt_pk_bf16_f32 v148, v88, v89
    v_cvt_pk_bf16_f32 v149, v90, v91
    s_add_u32 s33, s37, 2
    s_mul_i32 s33, s33, 40960
    buffer_store_dwordx2 v[144:145], v7, s[20:23], s33 offen sc1
    buffer_store_dwordx2 v[146:147], v8, s[20:23], s33 offen sc1
    s_mov_b64 exec, s[42:43]
    buffer_store_dwordx2 v[148:149], v9, s[20:23], s33 offen sc1
    s_mov_b64 exec, -1
    s_waitcnt lgkmcnt(0)
    v_max_f32 v188, v109, v141
    v_sub_f32 v189, v109, v188
    v_sub_f32 v190, v141, v188
    v_exp_f32 v189, v189
    v_exp_f32 v190, v190
    s_nop 0
    v_mul_f32 v191, v189, v108
    v_fmac_f32 v191, v190, v140
    v_rcp_f32 v191, v191
    s_nop 0
    v_mul_f32 v192, v189, v191
    v_mul_f32 v194, v190, v191
    v_mov_b32 v193, v192
    v_mov_b32 v195, v194
    v_pk_mul_f32 v[96:97], v[96:97], v[192:193]
    v_pk_mul_f32 v[98:99], v[98:99], v[192:193]
    v_pk_mul_f32 v[100:101], v[100:101], v[192:193]
    v_pk_mul_f32 v[102:103], v[102:103], v[192:193]
    v_pk_mul_f32 v[104:105], v[104:105], v[192:193]
    v_pk_mul_f32 v[106:107], v[106:107], v[192:193]
    v_pk_fma_f32 v[96:97], v[128:129], v[194:195], v[96:97]
    v_pk_fma_f32 v[98:99], v[130:131], v[194:195], v[98:99]
    v_pk_fma_f32 v[100:101], v[132:133], v[194:195], v[100:101]
    v_pk_fma_f32 v[102:103], v[134:135], v[194:195], v[102:103]
    v_pk_fma_f32 v[104:105], v[136:137], v[194:195], v[104:105]
    v_pk_fma_f32 v[106:107], v[138:139], v[194:195], v[106:107]
    v_cvt_pk_bf16_f32 v152, v96, v97
    v_cvt_pk_bf16_f32 v153, v98, v99
    v_cvt_pk_bf16_f32 v154, v100, v101
    v_cvt_pk_bf16_f32 v155, v102, v103
    v_cvt_pk_bf16_f32 v156, v104, v105
    v_cvt_pk_bf16_f32 v157, v106, v107
    s_add_u32 s33, s37, 3
    s_mul_i32 s33, s33, 40960
    buffer_store_dwordx2 v[152:153], v7, s[20:23], s33 offen sc1
    buffer_store_dwordx2 v[154:155], v8, s[20:23], s33 offen sc1
    s_mov_b64 exec, s[42:43]
    buffer_store_dwordx2 v[156:157], v9, s[20:23], s33 offen sc1
    s_mov_b64 exec, -1
    s_branch L_ca_fin
L_ca_fin:
    s_waitcnt vmcnt(0)
    s_barrier
    s_cmp_lg_u32 s3, 0
    s_cbranch_scc1 L_fl_19
    v_mov_b32 v248, s6
    buffer_store_dword v248, v252, s[96:99], 0 offen sc0 sc1
L_fl_19:
    s_branch C_O
C_O:
    s_and_b32 s37, s2, 7
    s_lshr_b32 s38, s2, 3
    s_and_b32 s29, s37, 3
    s_lshl_b32 s29, s29, 3
    s_and_b32 s39, s38, 7
    s_add_u32 s29, s29, s39
    s_lshr_b32 s37, s37, 2
    s_lshl_b32 s37, s37, 2
    s_lshr_b32 s38, s38, 3
    s_add_u32 s30, s37, s38
    s_mov_b32 s55, 10
    s_mov_b32 s45, 40
    s_branch C_NARROW
C_FB:
    s_and_b32 s37, s2, 7
    s_lshr_b32 s38, s2, 3
    s_and_b32 s29, s37, 3
    s_lshl_b32 s29, s29, 3
    s_and_b32 s39, s38, 7
    s_add_u32 s29, s29, s39
    s_lshr_b32 s37, s37, 2
    s_lshl_b32 s37, s37, 2
    s_lshr_b32 s38, s38, 3
    s_add_u32 s30, s37, s38
    s_mov_b32 s55, 27
    s_mov_b32 s45, 108
C_NARROW:
    s_cmp_lg_u32 s3, 0
    s_cbranch_scc1 L_w0_20
    s_and_b32 s60, s29, 1
    s_lshl_b32 s60, s60, 3
    s_add_u32 s60, s60, s30
    s_lshr_b32 s59, s29, 1
    s_cmp_eq_u32 s55, 27
    s_cbranch_scc1 L_snf_21
    s_lshl_b32 s59, s59, 4
    v_mov_b32 v12, v1
    v_add_u32 v12, s59, v12
    v_mov_b32 v13, s60
    v_cmp_gt_u32 vcc, 14, v1
    s_mov_b32 s58, s7
    s_mul_i32 s58, s58, 0x100000
    s_add_u32 s58, s58, 0x40000
    v_lshlrev_b32 v12, 9, v12
    v_lshl_add_u32 v252, v13, 4, v12
    v_add_u32 v252, s58, v252
    v_mov_b32 v12, s101
    v_cndmask_b32 v252, v12, v252, vcc
    s_branch L_snd_22
L_snf_21:
    v_lshlrev_b32 v12, 4, v1
    v_add_u32 v12, s59, v12
    v_mov_b32 v13, s60
    v_cmp_gt_u32 vcc, 15, v1
    s_add_u32 s58, s7, 1
    s_mul_i32 s58, s58, 0x100000
    s_add_u32 s58, s58, 0x0
    v_lshlrev_b32 v12, 9, v12
    v_lshl_add_u32 v252, v13, 4, v12
    v_add_u32 v252, s58, v252
    v_mov_b32 v12, s101
    v_cndmask_b32 v252, v12, v252, vcc
L_snd_22:
    s_lshl_b32 s37, s29, 3
    s_add_u32 s37, s37, s30
    s_lshl_b32 s37, s37, 9
    s_mov_b32 s38, 0x20000
    s_cmp_eq_u32 s55, 27
    s_cselect_b32 s38, 0x60000, s38
    s_cselect_b32 s39, 14, 32
    s_add_u32 s37, s37, s38
    s_mul_i32 s94, s7, 0x100000
    s_add_u32 s94, s94, s37
    v_lshlrev_b32 v244, 4, v1
    v_cmp_gt_u32 vcc, s39, v1
    v_mov_b32 v12, s101
    v_mov_b32 v245, s6
    v_cndmask_b32 v244, v12, v244, vcc
    v_cndmask_b32 v245, 0, v245, vcc
L_w0_20:
    s_load_dwordx2 s[46:47], s[0:1], 48
    s_and_b32 s40, s3, 1
    s_lshr_b32 s41, s3, 1
    s_mov_b32 s62, 8192
    s_mov_b32 s61, 10240
    s_mov_b32 s35, 0
    s_mov_b32 s48, 0
    s_cmp_eq_u32 s55, 27
    s_cselect_b32 s37, 2, 1
    s_cselect_b32 s39, s7, 0
    s_mov_b32 s31, s39
    s_lshl_b32 s38, s7, 1
    s_add_u32 s37, s37, s38
    s_lshl_b32 s57, s37, 18
    s_add_u32 s57, s57, 0xa00000
    s_mul_i32 s37, s37, 2621440
    s_add_u32 s24, s4, s57
    s_addc_u32 s25, s5, 0
    s_mov_b32 s26, 262144
    s_mov_b32 s27, 0x20000
    s_waitcnt lgkmcnt(0)
    s_cmp_eq_u32 s31, 1
    s_cselect_b32 s20, s46, s4
    s_cselect_b32 s21, s47, s5
    s_cselect_b32 s37, 0, s37
    s_add_u32 s20, s20, s37
    s_addc_u32 s21, s21, 0
    s_mov_b32 s22, 2621440
    s_mov_b32 s23, 0x20000
    v_lshlrev_b32 v4, 4, v1
    s_lshl_b32 s37, s40, 12
    s_lshl_b32 s38, s41, 10
    s_add_u32 s37, s37, s38
    v_add_u32 v8, s37, v4
    s_mul_i32 s37, s41, 2560
    s_add_u32 s37, s37, 49152
    v_add_u32 v9, s37, v4
    v_and_b32 v10, 15, v1
    v_lshlrev_b32 v10, 4, v10
    v_lshl_add_u32 v10, v2, 8, v10
    v_add_u32 v10, 2048, v10
    v_add_u32 v5, s37, v10
    v_mov_b32 v104, 0
    v_mov_b32 v105, 0
    v_mov_b32 v106, 0
    v_mov_b32 v107, 0
    v_mov_b32 v108, 0
    v_mov_b32 v109, 0
    v_mov_b32 v110, 0
    v_mov_b32 v111, 0
    v_mov_b32 v112, 0
    v_mov_b32 v113, 0
    v_mov_b32 v114, 0
    v_mov_b32 v115, 0
    v_mov_b32 v116, 0
    v_mov_b32 v117, 0
    v_mov_b32 v118, 0
    v_mov_b32 v119, 0
    v_mov_b32 v120, 0
    v_mov_b32 v121, 0
    v_mov_b32 v122, 0
    v_mov_b32 v123, 0
    v_mov_b32 v124, 0
    v_mov_b32 v125, 0
    v_mov_b32 v126, 0
    v_mov_b32 v127, 0
    v_mov_b32 v128, 0
    v_mov_b32 v129, 0
    v_mov_b32 v130, 0
    v_mov_b32 v131, 0
    v_mov_b32 v132, 0
    v_mov_b32 v133, 0
    v_mov_b32 v134, 0
    v_mov_b32 v135, 0
    v_mov_b32 v136, 0
    v_mov_b32 v137, 0
    v_mov_b32 v138, 0
    v_mov_b32 v139, 0
    v_mov_b32 v140, 0
    v_mov_b32 v141, 0
    v_mov_b32 v142, 0
    v_mov_b32 v143, 0
    v_mov_b32 v144, 0
    v_mov_b32 v145, 0
    v_mov_b32 v146, 0
    v_mov_b32 v147, 0
    v_mov_b32 v148, 0
    v_mov_b32 v149, 0
    v_mov_b32 v150, 0
    v_mov_b32 v151, 0
    s_lshl_b32 s37, s29, 1
    s_add_u32 s37, s37, s40
    s_mul_i32 s37, s37, 40
    s_mul_i32 s38, s30, 5
    s_add_u32 s37, s37, s38
    s_mul_i32 s38, s41, 3
    s_add_u32 s37, s37, s38
    s_lshl_b32 s57, s37, 10
    s_sub_u32 s36, s55, 1
    s_cmp_lg_u32 s3, 0
    s_cbranch_scc1 L_polld_24
    s_mov_b32 s95, 0x10000
    buffer_load_dword v248, v244, s[96:99], s94 offen sc0 sc1
L_poll_23:
    s_waitcnt vmcnt(0)
    v_cmp_eq_u32 vcc, v248, v245
    s_nop 1
    s_cmp_eq_u64 vcc, exec
    s_cbranch_scc1 L_polld_24
    buffer_load_dword v248, v244, s[96:99], s94 offen sc0 sc1
    s_sub_u32 s95, s95, 1
    s_cmp_lg_u32 s95, 0
    s_cbranch_scc1 L_poll_23
L_polld_24:
    s_barrier
    s_cmp_eq_u32 s55, 10
    s_cselect_b32 s37, s7, 1
    s_cmp_lg_u32 s37, 0
    s_cbranch_scc1 L_cn_nores
    s_add_u32 s16, s4, 0x0
    s_addc_u32 s17, s5, 0
    s_mov_b32 s18, 2621440
    s_mov_b32 s19, 0x20000
    buffer_load_dwordx4 v[232:235], v4, s[16:19], s57 offen
    buffer_load_dwordx4 v[236:239], v4, s[16:19], s57 offen offset:1024
    buffer_load_dwordx4 v[240:243], v4, s[16:19], s57 offen offset:2048
L_cn_nores:
    s_barrier
    ds_read_b128 v[52:55], v8 offset:0
    ds_read_b128 v[40:43], v9 offset:0
    ds_read_b128 v[44:47], v9 offset:1024
    ds_read_b128 v[48:51], v5 offset:0
    ds_read_b128 v[68:71], v8 offset:2048
    ds_read_b128 v[56:59], v9 offset:5120
    ds_read_b128 v[60:63], v9 offset:6144
    ds_read_b128 v[64:67], v5 offset:5120
    s_lshr_b32 s36, s36, 1
.p2align 6
L_cn_loop:
    s_waitcnt lgkmcnt(0)
    s_add_u32 s35, s35, 1
    s_cmp_eq_u32 s35, 6
    s_cselect_b32 s38, 0xffff6000, s62
    s_cselect_b32 s35, 0, s35
    v_add_u32 v8, s38, v8
    s_add_u32 s48, s48, 1
    s_cmp_eq_u32 s48, 10
    s_cselect_b32 s39, 0xfffe9800, s61
    s_cselect_b32 s48, 0, s48
    v_add_u32 v9, s39, v9
    v_add_u32 v5, s39, v5
    v_mfma_f32_32x32x16_bf16 v[104:119], v[40:43], v[52:55], v[104:119]
    s_barrier
    ds_read_b128 v[84:87], v8 offset:0
    ds_read_b128 v[72:75], v9 offset:0
    v_mfma_f32_32x32x16_bf16 v[120:135], v[44:47], v[52:55], v[120:135]
    ds_read_b128 v[76:79], v9 offset:1024
    ds_read_b128 v[80:83], v5 offset:0
    v_mfma_f32_32x32x16_bf16 v[136:151], v[48:51], v[52:55], v[136:151]
    ds_read_b128 v[100:103], v8 offset:2048
    ds_read_b128 v[88:91], v9 offset:5120
    v_mfma_f32_32x32x16_bf16 v[104:119], v[56:59], v[68:71], v[104:119]
    ds_read_b128 v[92:95], v9 offset:6144
    ds_read_b128 v[96:99], v5 offset:5120
    v_mfma_f32_32x32x16_bf16 v[120:135], v[60:63], v[68:71], v[120:135]
    v_mfma_f32_32x32x16_bf16 v[136:151], v[64:67], v[68:71], v[136:151]
    s_waitcnt lgkmcnt(0)
    s_add_u32 s35, s35, 1
    s_cmp_eq_u32 s35, 6
    s_cselect_b32 s38, 0xffff6000, s62
    s_cselect_b32 s35, 0, s35
    v_add_u32 v8, s38, v8
    s_add_u32 s48, s48, 1
    s_cmp_eq_u32 s48, 10
    s_cselect_b32 s39, 0xfffe9800, s61
    s_cselect_b32 s48, 0, s48
    v_add_u32 v9, s39, v9
    v_add_u32 v5, s39, v5
    v_mfma_f32_32x32x16_bf16 v[104:119], v[72:75], v[84:87], v[104:119]
    s_barrier
    ds_read_b128 v[52:55], v8 offset:0
    ds_read_b128 v[40:43], v9 offset:0
    v_mfma_f32_32x32x16_bf16 v[120:135], v[76:79], v[84:87], v[120:135]
    ds_read_b128 v[44:47], v9 offset:1024
    ds_read_b128 v[48:51], v5 offset:0
    v_mfma_f32_32x32x16_bf16 v[136:151], v[80:83], v[84:87], v[136:151]
    ds_read_b128 v[68:71], v8 offset:2048
    ds_read_b128 v[56:59], v9 offset:5120
    v_mfma_f32_32x32x16_bf16 v[104:119], v[88:91], v[100:103], v[104:119]
    ds_read_b128 v[60:63], v9 offset:6144
    ds_read_b128 v[64:67], v5 offset:5120
    v_mfma_f32_32x32x16_bf16 v[120:135], v[92:95], v[100:103], v[120:135]
    v_mfma_f32_32x32x16_bf16 v[136:151], v[96:99], v[100:103], v[136:151]
    s_sub_u32 s36, s36, 1
    s_cmp_lg_u32 s36, 0
    s_cbranch_scc1 L_cn_loop
    s_cmp_eq_u32 s55, 27
    s_cbranch_scc1 L_cn_odd
    s_waitcnt lgkmcnt(0)
    s_add_u32 s35, s35, 1
    s_cmp_eq_u32 s35, 6
    s_cselect_b32 s38, 0xffff6000, s62
    s_cselect_b32 s35, 0, s35
    v_add_u32 v8, s38, v8
    s_add_u32 s48, s48, 1
    s_cmp_eq_u32 s48, 10
    s_cselect_b32 s39, 0xfffe9800, s61
    s_cselect_b32 s48, 0, s48
    v_add_u32 v9, s39, v9
    v_add_u32 v5, s39, v5
    v_mfma_f32_32x32x16_bf16 v[104:119], v[40:43], v[52:55], v[104:119]
    s_barrier
    ds_read_b128 v[84:87], v8 offset:0
    ds_read_b128 v[72:75], v9 offset:0
    v_mfma_f32_32x32x16_bf16 v[120:135], v[44:47], v[52:55], v[120:135]
    ds_read_b128 v[76:79], v9 offset:1024
    ds_read_b128 v[80:83], v5 offset:0
    v_mfma_f32_32x32x16_bf16 v[136:151], v[48:51], v[52:55], v[136:151]
    ds_read_b128 v[100:103], v8 offset:2048
    ds_read_b128 v[88:91], v9 offset:5120
    v_mfma_f32_32x32x16_bf16 v[104:119], v[56:59], v[68:71], v[104:119]
    ds_read_b128 v[92:95], v9 offset:6144
    ds_read_b128 v[96:99], v5 offset:5120
    v_mfma_f32_32x32x16_bf16 v[120:135], v[60:63], v[68:71], v[120:135]
    v_mfma_f32_32x32x16_bf16 v[136:151], v[64:67], v[68:71], v[136:151]
    s_waitcnt lgkmcnt(0)
    v_mfma_f32_32x32x16_bf16 v[104:119], v[72:75], v[84:87], v[104:119]
    v_mfma_f32_32x32x16_bf16 v[120:135], v[76:79], v[84:87], v[120:135]
    v_mfma_f32_32x32x16_bf16 v[136:151], v[80:83], v[84:87], v[136:151]
    v_mfma_f32_32x32x16_bf16 v[104:119], v[88:91], v[100:103], v[104:119]
    v_mfma_f32_32x32x16_bf16 v[120:135], v[92:95], v[100:103], v[120:135]
    v_mfma_f32_32x32x16_bf16 v[136:151], v[96:99], v[100:103], v[136:151]
    s_branch L_cn_loopdone
L_cn_odd:
    s_waitcnt lgkmcnt(0)
    v_mfma_f32_32x32x16_bf16 v[104:119], v[40:43], v[52:55], v[104:119]
    v_mfma_f32_32x32x16_bf16 v[120:135], v[44:47], v[52:55], v[120:135]
    v_mfma_f32_32x32x16_bf16 v[136:151], v[48:51], v[52:55], v[136:151]
    v_mfma_f32_32x32x16_bf16 v[104:119], v[56:59], v[68:71], v[104:119]
    v_mfma_f32_32x32x16_bf16 v[120:135], v[60:63], v[68:71], v[120:135]
    v_mfma_f32_32x32x16_bf16 v[136:151], v[64:67], v[68:71], v[136:151]
L_cn_loopdone:
    s_mul_i32 s37, s40, 4096
    s_mul_i32 s38, s40, 6144
    s_add_u32 s37, s37, 120832
    s_add_u32 s38, s38, 129024
    s_cmp_eq_u32 s41, 0
    s_cselect_b32 s39, s37, s38
    s_cselect_b32 s38, s38, s37
    v_add_u32 v10, s39, v4
    v_add_u32 v11, s38, v4
    s_lshl_b32 s37, s29, 1
    s_add_u32 s37, s37, s40
    s_cmp_eq_u32 s41, 0
    s_cbranch_scc0 L_cn_wk1
    ds_write_b128 v10, v[128:131] offset:0
    ds_write_b128 v10, v[132:135] offset:1024
    ds_write_b128 v10, v[136:139] offset:2048
    ds_write_b128 v10, v[140:143] offset:3072
    s_waitcnt lgkmcnt(0)
    s_barrier
    ds_read_b128 v[152:155], v11 offset:0
    ds_read_b128 v[156:159], v11 offset:1024
    ds_read_b128 v[160:163], v11 offset:2048
    ds_read_b128 v[164:167], v11 offset:3072
    ds_read_b128 v[168:171], v11 offset:4096
    ds_read_b128 v[172:175], v11 offset:5120
    s_waitcnt vmcnt(0) lgkmcnt(0)
    v_pk_add_f32 v[104:105], v[104:105], v[152:153]
    v_pk_add_f32 v[106:107], v[106:107], v[154:155]
    v_pk_add_f32 v[108:109], v[108:109], v[156:157]
    v_pk_add_f32 v[110:111], v[110:111], v[158:159]
    v_lshlrev_b32 v152, 16, v232
    v_and_b32 v153, 0xffff0000, v232
    v_lshlrev_b32 v154, 16, v233
    v_and_b32 v155, 0xffff0000, v233
    v_lshlrev_b32 v156, 16, v234
    v_and_b32 v157, 0xffff0000, v234
    v_lshlrev_b32 v158, 16, v235
    v_and_b32 v159, 0xffff0000, v235
    v_pk_add_f32 v[104:105], v[104:105], v[152:153]
    v_pk_add_f32 v[106:107], v[106:107], v[154:155]
    v_pk_add_f32 v[108:109], v[108:109], v[156:157]
    v_pk_add_f32 v[110:111], v[110:111], v[158:159]
    v_cvt_pk_bf16_f32 v232, v104, v105
    v_cvt_pk_bf16_f32 v233, v106, v107
    v_cvt_pk_bf16_f32 v234, v108, v109
    v_cvt_pk_bf16_f32 v235, v110, v111
    v_pk_add_f32 v[112:113], v[112:113], v[160:161]
    v_pk_add_f32 v[114:115], v[114:115], v[162:163]
    v_pk_add_f32 v[116:117], v[116:117], v[164:165]
    v_pk_add_f32 v[118:119], v[118:119], v[166:167]
    v_lshlrev_b32 v160, 16, v236
    v_and_b32 v161, 0xffff0000, v236
    v_lshlrev_b32 v162, 16, v237
    v_and_b32 v163, 0xffff0000, v237
    v_lshlrev_b32 v164, 16, v238
    v_and_b32 v165, 0xffff0000, v238
    v_lshlrev_b32 v166, 16, v239
    v_and_b32 v167, 0xffff0000, v239
    v_pk_add_f32 v[112:113], v[112:113], v[160:161]
    v_pk_add_f32 v[114:115], v[114:115], v[162:163]
    v_pk_add_f32 v[116:117], v[116:117], v[164:165]
    v_pk_add_f32 v[118:119], v[118:119], v[166:167]
    v_cvt_pk_bf16_f32 v236, v112, v113
    v_cvt_pk_bf16_f32 v237, v114, v115
    v_cvt_pk_bf16_f32 v238, v116, v117
    v_cvt_pk_bf16_f32 v239, v118, v119
    v_pk_add_f32 v[120:121], v[120:121], v[168:169]
    v_pk_add_f32 v[122:123], v[122:123], v[170:171]
    v_pk_add_f32 v[124:125], v[124:125], v[172:173]
    v_pk_add_f32 v[126:127], v[126:127], v[174:175]
    v_lshlrev_b32 v168, 16, v240
    v_and_b32 v169, 0xffff0000, v240
    v_lshlrev_b32 v170, 16, v241
    v_and_b32 v171, 0xffff0000, v241
    v_lshlrev_b32 v172, 16, v242
    v_and_b32 v173, 0xffff0000, v242
    v_lshlrev_b32 v174, 16, v243
    v_and_b32 v175, 0xffff0000, v243
    v_pk_add_f32 v[120:121], v[120:121], v[168:169]
    v_pk_add_f32 v[122:123], v[122:123], v[170:171]
    v_pk_add_f32 v[124:125], v[124:125], v[172:173]
    v_pk_add_f32 v[126:127], v[126:127], v[174:175]
    v_cvt_pk_bf16_f32 v240, v120, v121
    v_cvt_pk_bf16_f32 v241, v122, v123
    v_cvt_pk_bf16_f32 v242, v124, v125
    v_cvt_pk_bf16_f32 v243, v126, v127
    s_cmp_eq_u32 s31, 1
    s_cbranch_scc1 L_cn_rowmajor_0
    buffer_store_dwordx4 v[232:235], v4, s[20:23], s57 offen sc1
    buffer_store_dwordx4 v[236:239], v4, s[20:23], s57 offen offset:1024 sc1
    buffer_store_dwordx4 v[240:243], v4, s[20:23], s57 offen offset:2048 sc1
    v_pk_mul_f32 v[178:179], v[104:105], v[104:105]
    v_pk_add_f32 v[176:177], v[104:105], v[106:107]
    v_pk_fma_f32 v[178:179], v[106:107], v[106:107], v[178:179]
    v_pk_fma_f32 v[178:179], v[108:109], v[108:109], v[178:179]
    v_pk_add_f32 v[176:177], v[176:177], v[108:109]
    v_pk_fma_f32 v[178:179], v[110:111], v[110:111], v[178:179]
    v_pk_add_f32 v[176:177], v[176:177], v[110:111]
    v_pk_fma_f32 v[178:179], v[112:113], v[112:113], v[178:179]
    v_pk_add_f32 v[176:177], v[176:177], v[112:113]
    v_pk_fma_f32 v[178:179], v[114:115], v[114:115], v[178:179]
    v_pk_add_f32 v[176:177], v[176:177], v[114:115]
    v_pk_fma_f32 v[178:179], v[116:117], v[116:117], v[178:179]
    v_pk_add_f32 v[176:177], v[176:177], v[116:117]
    v_pk_fma_f32 v[178:179], v[118:119], v[118:119], v[178:179]
    v_pk_add_f32 v[176:177], v[176:177], v[118:119]
    v_pk_fma_f32 v[178:179], v[120:121], v[120:121], v[178:179]
    v_pk_add_f32 v[176:177], v[176:177], v[120:121]
    v_pk_fma_f32 v[178:179], v[122:123], v[122:123], v[178:179]
    v_pk_add_f32 v[176:177], v[176:177], v[122:123]
    v_pk_fma_f32 v[178:179], v[124:125], v[124:125], v[178:179]
    v_pk_add_f32 v[176:177], v[176:177], v[124:125]
    v_pk_fma_f32 v[178:179], v[126:127], v[126:127], v[178:179]
    v_pk_add_f32 v[176:177], v[176:177], v[126:127]
    v_add_f32 v12, v176, v177
    v_add_f32 v13, v178, v179
    v_mov_b32 v14, v12
    s_nop 1
    v_permlane32_swap_b32 v12, v14
    v_add_f32 v12, v12, v14
    v_mov_b32 v15, v13
    s_nop 1
    v_permlane32_swap_b32 v13, v15
    v_add_f32 v13, v13, v15
    s_lshl_b32 s37, s37, 12
    s_lshl_b32 s39, s30, 9
    s_add_u32 s37, s37, s39
    s_add_u32 s37, s37, 0
    v_lshlrev_b32 v14, 4, v3
    buffer_store_dwordx2 v[12:13], v14, s[24:27], s37 offen sc1
    s_branch L_cn_fin
L_cn_rowmajor_0:
    s_lshl_b32 s37, s37, 5
    v_add_u32 v14, s37, v3
    v_mul_u32_u24 v14, 1280, v14
    v_lshlrev_b32 v15, 4, v2
    v_add_u32 v14, v14, v15
    s_mul_i32 s39, s30, 160
    v_permlane32_swap_b32 v232, v234
    v_permlane32_swap_b32 v233, v235
    v_permlane32_swap_b32 v236, v238
    v_permlane32_swap_b32 v237, v239
    v_permlane32_swap_b32 v240, v242
    v_permlane32_swap_b32 v241, v243
    buffer_store_dwordx4 v[232:235], v14, s[20:23], s39 offen
    buffer_store_dwordx4 v[236:239], v14, s[20:23], s39 offen offset:32
    buffer_store_dwordx4 v[240:243], v14, s[20:23], s39 offen offset:64
    s_branch L_end
L_cn_wk1:
    ds_write_b128 v10, v[104:107] offset:0
    ds_write_b128 v10, v[108:111] offset:1024
    ds_write_b128 v10, v[112:115] offset:2048
    ds_write_b128 v10, v[116:119] offset:3072
    ds_write_b128 v10, v[120:123] offset:4096
    ds_write_b128 v10, v[124:127] offset:5120
    s_waitcnt lgkmcnt(0)
    s_barrier
    ds_read_b128 v[152:155], v11 offset:0
    ds_read_b128 v[156:159], v11 offset:1024
    ds_read_b128 v[160:163], v11 offset:2048
    ds_read_b128 v[164:167], v11 offset:3072
    s_waitcnt vmcnt(0) lgkmcnt(0)
    v_pk_add_f32 v[128:129], v[128:129], v[152:153]
    v_pk_add_f32 v[130:131], v[130:131], v[154:155]
    v_pk_add_f32 v[132:133], v[132:133], v[156:157]
    v_pk_add_f32 v[134:135], v[134:135], v[158:159]
    v_lshlrev_b32 v152, 16, v232
    v_and_b32 v153, 0xffff0000, v232
    v_lshlrev_b32 v154, 16, v233
    v_and_b32 v155, 0xffff0000, v233
    v_lshlrev_b32 v156, 16, v234
    v_and_b32 v157, 0xffff0000, v234
    v_lshlrev_b32 v158, 16, v235
    v_and_b32 v159, 0xffff0000, v235
    v_pk_add_f32 v[128:129], v[128:129], v[152:153]
    v_pk_add_f32 v[130:131], v[130:131], v[154:155]
    v_pk_add_f32 v[132:133], v[132:133], v[156:157]
    v_pk_add_f32 v[134:135], v[134:135], v[158:159]
    v_cvt_pk_bf16_f32 v232, v128, v129
    v_cvt_pk_bf16_f32 v233, v130, v131
    v_cvt_pk_bf16_f32 v234, v132, v133
    v_cvt_pk_bf16_f32 v235, v134, v135
    v_pk_add_f32 v[136:137], v[136:137], v[160:161]
    v_pk_add_f32 v[138:139], v[138:139], v[162:163]
    v_pk_add_f32 v[140:141], v[140:141], v[164:165]
    v_pk_add_f32 v[142:143], v[142:143], v[166:167]
    v_lshlrev_b32 v160, 16, v236
    v_and_b32 v161, 0xffff0000, v236
    v_lshlrev_b32 v162, 16, v237
    v_and_b32 v163, 0xffff0000, v237
    v_lshlrev_b32 v164, 16, v238
    v_and_b32 v165, 0xffff0000, v238
    v_lshlrev_b32 v166, 16, v239
    v_and_b32 v167, 0xffff0000, v239
    v_pk_add_f32 v[136:137], v[136:137], v[160:161]
    v_pk_add_f32 v[138:139], v[138:139], v[162:163]
    v_pk_add_f32 v[140:141], v[140:141], v[164:165]
    v_pk_add_f32 v[142:143], v[142:143], v[166:167]
    v_cvt_pk_bf16_f32 v236, v136, v137
    v_cvt_pk_bf16_f32 v237, v138, v139
    v_cvt_pk_bf16_f32 v238, v140, v141
    v_cvt_pk_bf16_f32 v239, v142, v143
    s_cmp_eq_u32 s31, 1
    s_cbranch_scc1 L_cn_rowmajor_1
    buffer_store_dwordx4 v[232:235], v4, s[20:23], s57 offen sc1
    buffer_store_dwordx4 v[236:239], v4, s[20:23], s57 offen offset:1024 sc1
    v_pk_mul_f32 v[178:179], v[128:129], v[128:129]
    v_pk_add_f32 v[176:177], v[128:129], v[130:131]
    v_pk_fma_f32 v[178:179], v[130:131], v[130:131], v[178:179]
    v_pk_fma_f32 v[178:179], v[132:133], v[132:133], v[178:179]
    v_pk_add_f32 v[176:177], v[176:177], v[132:133]
    v_pk_fma_f32 v[178:179], v[134:135], v[134:135], v[178:179]
    v_pk_add_f32 v[176:177], v[176:177], v[134:135]
    v_pk_fma_f32 v[178:179], v[136:137], v[136:137], v[178:179]
    v_pk_add_f32 v[176:177], v[176:177], v[136:137]
    v_pk_fma_f32 v[178:179], v[138:139], v[138:139], v[178:179]
    v_pk_add_f32 v[176:177], v[176:177], v[138:139]
    v_pk_fma_f32 v[178:179], v[140:141], v[140:141], v[178:179]
    v_pk_add_f32 v[176:177], v[176:177], v[140:141]
    v_pk_fma_f32 v[178:179], v[142:143], v[142:143], v[178:179]
    v_pk_add_f32 v[176:177], v[176:177], v[142:143]
    v_add_f32 v12, v176, v177
    v_add_f32 v13, v178, v179
    v_mov_b32 v14, v12
    s_nop 1
    v_permlane32_swap_b32 v12, v14
    v_add_f32 v12, v12, v14
    v_mov_b32 v15, v13
    s_nop 1
    v_permlane32_swap_b32 v13, v15
    v_add_f32 v13, v13, v15
    s_lshl_b32 s37, s37, 12
    s_lshl_b32 s39, s30, 9
    s_add_u32 s37, s37, s39
    s_add_u32 s37, s37, 8
    v_lshlrev_b32 v14, 4, v3
    buffer_store_dwordx2 v[12:13], v14, s[24:27], s37 offen sc1
    s_branch L_cn_fin
L_cn_rowmajor_1:
    s_lshl_b32 s37, s37, 5
    v_add_u32 v14, s37, v3
    v_mul_u32_u24 v14, 1280, v14
    v_lshlrev_b32 v15, 4, v2
    v_add_u32 v14, v14, v15
    s_mul_i32 s39, s30, 160
    v_permlane32_swap_b32 v232, v234
    v_permlane32_swap_b32 v233, v235
    v_permlane32_swap_b32 v236, v238
    v_permlane32_swap_b32 v237, v239
    buffer_store_dwordx4 v[232:235], v14, s[20:23], s39 offen offset:96
    buffer_store_dwordx4 v[236:239], v14, s[20:23], s39 offen offset:128
    s_branch L_end
L_cn_fin:
    s_waitcnt vmcnt(0)
    s_barrier
    s_cmp_lg_u32 s3, 0
    s_cbranch_scc1 L_fl_25
    v_mov_b32 v248, s6
    buffer_store_dword v248, v252, s[96:99], 0 offen sc0 sc1
L_fl_25:
    s_cmp_eq_u32 s55, 10
    s_cbranch_scc1 C_FA
    s_add_u32 s7, s7, 1
    s_branch C_QKV
.p2align 6
L_loader:
    s_load_dwordx2 s[50:51], s[0:1], 8
    s_load_dwordx2 s[52:53], s[0:1], 56
    s_waitcnt lgkmcnt(0)
    s_mov_b32 s12, s50
    s_mov_b32 s13, s51
    s_mov_b32 s14, 2457600
    s_mov_b32 s15, 0x20000
    s_add_u32 s8, s4, 0x0
    s_addc_u32 s9, s5, 0
    s_mov_b32 s10, 2621440
    s_mov_b32 s11, 0x20000
    v_mov_b32 v4, 0
    v_mov_b32 v5, 0
    v_mov_b32 v6, 0
    v_mov_b32 v7, 0
    v_mov_b32 v8, 0
    s_or_b32 s92, s2, s100
    s_cmp_lg_u32 s92, 0
    s_cbranch_scc1 L_nonce_made
    s_mov_b32 s56, s52
    s_mov_b32 s57, s53
    s_mov_b32 s58, 256
    s_mov_b32 s59, 0x20000
    v_mov_b32 v16, 2129920
    buffer_load_dword v14, v16, s[96:99], 0 offen sc0 sc1
    v_lshlrev_b32 v17, 7, v1
    s_waitcnt vmcnt(0)
    v_add_u32 v14, 1, v14
    v_mov_b32 v15, 1
    s_mov_b64 exec, 3
    buffer_store_dwordx2 v[14:15], v17, s[56:59], 0 offen sc0 sc1
    s_mov_b64 exec, 1
    buffer_store_dword v14, v16, s[96:99], 0 offen sc0 sc1
    s_mov_b64 exec, -1
L_nonce_made:
    s_cmp_eq_u32 s100, 0
    s_cbranch_scc1 L_cpfs_27
    s_getpc_b64 s[60:61]
L_cpf_26:
    s_sub_u32 s60, s60, L_cpf_26-interleave_layers__mha_block__dense_activation_silu__prompt_kernel
    s_subb_u32 s61, s61, 0
    s_mov_b32 s62, L_code_end-interleave_layers__mha_block__dense_activation_silu__prompt_kernel
    s_mov_b32 s63, 0x20000
    s_lshr_b32 s92, s2, 3
    s_mul_i32 s92, s92, 3
    s_add_u32 s92, s92, s100
    s_sub_u32 s92, s92, 1
    s_lshl_b32 s92, s92, 10
    v_lshlrev_b32 v24, 4, v1
    buffer_load_dwordx4 v[100:103], v24, s[60:63], s92 offen
L_cpfs_27:
    s_load_dwordx2 s[20:21], s[0:1], 32
    s_load_dwordx2 s[22:23], s[0:1], 40
    v_and_b32 v9, 255, v0
    s_cmp_ge_u32 s2, 228
    s_cselect_b32 s85, 1, 0
    s_waitcnt lgkmcnt(0)
    s_cmp_ge_u32 s2, 120
    s_cbranch_scc1 L_lp_csw1
    s_mov_b32 s40, s50
    s_mov_b32 s41, s51
    s_mov_b32 s42, 2457600
    s_mov_b32 s43, 0x20000
    s_add_u32 s44, s4, 0xb00000
    s_addc_u32 s45, s5, 0
    s_mov_b32 s46, 30720
    s_mov_b32 s47, 0x20000
    s_mov_b32 s80, 3840
    s_mov_b32 s81, 7680
    s_mov_b32 s82, s2
    s_branch L_lp_csgo
L_lp_csw1:
    s_mov_b32 s40, s20
    s_mov_b32 s41, s21
    s_mov_b32 s42, 2211840
    s_mov_b32 s43, 0x20000
    s_add_u32 s44, s4, 0xb08000
    s_addc_u32 s45, s5, 0
    s_mov_b32 s46, 27648
    s_mov_b32 s47, 0x20000
    s_mov_b32 s80, 3456
    s_mov_b32 s81, 6912
    s_sub_u32 s82, s2, 120
L_lp_csgo:
    s_lshr_b32 s83, s82, 2
    s_and_b32 s84, s82, 3
    v_lshrrev_b32 v6, 3, v9
    s_mul_i32 s76, s84, 160
    v_add_u32 v6, s76, v6
    v_mul_lo_u32 v6, v6, s80
    v_and_b32 v7, 7, v9
    v_lshlrev_b32 v7, 4, v7
    v_add_u32 v6, v6, v7
    s_lshl_b32 s76, s83, 7
    v_add_u32 v6, s76, v6
    s_lshl_b32 s86, s80, 5
    s_cmp_eq_u32 s85, 1
    s_cselect_b32 s87, s101, 0
    buffer_load_dwordx4 v[20:23], v6, s[40:43], s87 offen
    s_add_u32 s87, s87, s86
    buffer_load_dwordx4 v[24:27], v6, s[40:43], s87 offen
    s_add_u32 s87, s87, s86
    buffer_load_dwordx4 v[28:31], v6, s[40:43], s87 offen
    s_add_u32 s87, s87, s86
    buffer_load_dwordx4 v[32:35], v6, s[40:43], s87 offen
    s_add_u32 s87, s87, s86
    buffer_load_dwordx4 v[36:39], v6, s[40:43], s87 offen
    s_add_u32 s68, s4, 0x1500000
    s_addc_u32 s69, s5, 0
    s_mov_b32 s70, 2883584
    s_mov_b32 s71, 0x20000
    s_add_u32 s72, s4, 0x2900000
    s_addc_u32 s73, s5, 0
    s_mov_b32 s74, 2883584
    s_mov_b32 s75, 0x20000
    v_lshrrev_b32 v95, 1, v1
    s_lshl_b32 s76, s2, 5
    v_add_u32 v95, s76, v95
    v_mul_u32_u24 v95, 352, v95
    v_and_b32 v94, 1, v1
    v_lshlrev_b32 v96, 4, v94
    v_add_u32 v95, v95, v96
    v_add_u32 v95, 320, v95
    v_mov_b32 v96, 0x3f803f80
    v_cmp_eq_u32 vcc, 0, v94
    s_nop 1
    v_cndmask_b32 v96, 0, v96, vcc
    v_mov_b32 v97, v96
    v_mov_b32 v98, v96
    v_mov_b32 v99, v96
    v_cmp_gt_u32 vcc, 64, v9
    v_mov_b32 v94, s101
    s_nop 0
    v_cndmask_b32 v95, v94, v95, vcc
    buffer_store_dwordx4 v[96:99], v95, s[68:71], 0 offen sc1
    buffer_store_dwordx4 v[96:99], v95, s[72:75], 0 offen sc1
    s_waitcnt vmcnt(2)
    v_mov_b32 v64, 0
    v_mov_b32 v65, 0
    v_mov_b32 v66, 0
    v_mov_b32 v67, 0
    v_mov_b32 v68, 0
    v_mov_b32 v69, 0
    v_mov_b32 v70, 0
    v_mov_b32 v71, 0
    v_lshlrev_b32 v58, 16, v20
    v_and_b32 v59, 0xffff0000, v20
    v_add_f32 v64, v64, v58
    v_add_f32 v65, v65, v59
    v_lshlrev_b32 v58, 16, v21
    v_and_b32 v59, 0xffff0000, v21
    v_add_f32 v66, v66, v58
    v_add_f32 v67, v67, v59
    v_lshlrev_b32 v58, 16, v22
    v_and_b32 v59, 0xffff0000, v22
    v_add_f32 v68, v68, v58
    v_add_f32 v69, v69, v59
    v_lshlrev_b32 v58, 16, v23
    v_and_b32 v59, 0xffff0000, v23
    v_add_f32 v70, v70, v58
    v_add_f32 v71, v71, v59
    v_lshlrev_b32 v58, 16, v24
    v_and_b32 v59, 0xffff0000, v24
    v_add_f32 v64, v64, v58
    v_add_f32 v65, v65, v59
    v_lshlrev_b32 v58, 16, v25
    v_and_b32 v59, 0xffff0000, v25
    v_add_f32 v66, v66, v58
    v_add_f32 v67, v67, v59
    v_lshlrev_b32 v58, 16, v26
    v_and_b32 v59, 0xffff0000, v26
    v_add_f32 v68, v68, v58
    v_add_f32 v69, v69, v59
    v_lshlrev_b32 v58, 16, v27
    v_and_b32 v59, 0xffff0000, v27
    v_add_f32 v70, v70, v58
    v_add_f32 v71, v71, v59
    v_lshlrev_b32 v58, 16, v28
    v_and_b32 v59, 0xffff0000, v28
    v_add_f32 v64, v64, v58
    v_add_f32 v65, v65, v59
    v_lshlrev_b32 v58, 16, v29
    v_and_b32 v59, 0xffff0000, v29
    v_add_f32 v66, v66, v58
    v_add_f32 v67, v67, v59
    v_lshlrev_b32 v58, 16, v30
    v_and_b32 v59, 0xffff0000, v30
    v_add_f32 v68, v68, v58
    v_add_f32 v69, v69, v59
    v_lshlrev_b32 v58, 16, v31
    v_and_b32 v59, 0xffff0000, v31
    v_add_f32 v70, v70, v58
    v_add_f32 v71, v71, v59
    v_lshlrev_b32 v58, 16, v32
    v_and_b32 v59, 0xffff0000, v32
    v_add_f32 v64, v64, v58
    v_add_f32 v65, v65, v59
    v_lshlrev_b32 v58, 16, v33
    v_and_b32 v59, 0xffff0000, v33
    v_add_f32 v66, v66, v58
    v_add_f32 v67, v67, v59
    v_lshlrev_b32 v58, 16, v34
    v_and_b32 v59, 0xffff0000, v34
    v_add_f32 v68, v68, v58
    v_add_f32 v69, v69, v59
    v_lshlrev_b32 v58, 16, v35
    v_and_b32 v59, 0xffff0000, v35
    v_add_f32 v70, v70, v58
    v_add_f32 v71, v71, v59
    v_lshlrev_b32 v58, 16, v36
    v_and_b32 v59, 0xffff0000, v36
    v_add_f32 v64, v64, v58
    v_add_f32 v65, v65, v59
    v_lshlrev_b32 v58, 16, v37
    v_and_b32 v59, 0xffff0000, v37
    v_add_f32 v66, v66, v58
    v_add_f32 v67, v67, v59
    v_lshlrev_b32 v58, 16, v38
    v_and_b32 v59, 0xffff0000, v38
    v_add_f32 v68, v68, v58
    v_add_f32 v69, v69, v59
    v_lshlrev_b32 v58, 16, v39
    v_and_b32 v59, 0xffff0000, v39
    v_add_f32 v70, v70, v58
    v_add_f32 v71, v71, v59
    v_lshlrev_b32 v58, 5, v9
    v_add_u32 v58, 126976, v58
    ds_write_b128 v58, v[64:67]
    ds_write_b128 v58, v[68:71] offset:16
    s_waitcnt lgkmcnt(0)
    s_barrier
    v_lshlrev_b32 v58, 2, v1
    s_lshl_b32 s76, s100, 11
    s_add_u32 s76, s76, 126976
    v_add_u32 v58, s76, v58
    ds_read_b32 v64, v58 offset:0
    ds_read_b32 v65, v58 offset:256
    ds_read_b32 v66, v58 offset:512
    ds_read_b32 v67, v58 offset:768
    ds_read_b32 v68, v58 offset:1024
    ds_read_b32 v69, v58 offset:1280
    ds_read_b32 v70, v58 offset:1536
    ds_read_b32 v71, v58 offset:1792
    s_waitcnt lgkmcnt(0)
    v_add_f32 v64, v64, v65
    v_add_f32 v66, v66, v67
    v_add_f32 v68, v68, v69
    v_add_f32 v70, v70, v71
    v_add_f32 v64, v64, v66
    v_add_f32 v68, v68, v70
    v_add_f32 v64, v64, v68
    v_lshlrev_b32 v58, 2, v9
    v_add_u32 v58, 126976, v58
    s_barrier
    ds_write_b32 v58, v64
    s_waitcnt lgkmcnt(0)
    s_barrier
    v_lshlrev_b32 v59, 2, v1
    v_add_u32 v58, 126976, v59
    ds_read_b32 v64, v58
    ds_read_b32 v65, v58 offset:256
    ds_read_b32 v66, v58 offset:512
    ds_read_b32 v67, v58 offset:768
    s_waitcnt lgkmcnt(0)
    v_add_f32 v64, v64, v65
    v_add_f32 v66, v66, v67
    v_add_f32 v64, v64, v66
    s_mul_i32 s76, s84, s81
    s_lshl_b32 s77, s83, 8
    s_add_u32 s76, s76, s77
    s_cmp_lg_u32 s100, 0
    s_cselect_b32 s76, s101, s76
    s_cmp_eq_u32 s85, 1
    s_cselect_b32 s76, s101, s76
    v_add_u32 v59, s76, v59
    buffer_store_dword v64, v59, s[44:47], 0 offen sc1
    s_waitcnt vmcnt(0)
    s_barrier
    v_mov_b32 v4, 0
    v_mov_b32 v5, 0
    v_mov_b32 v6, 0
    v_mov_b32 v7, 0
    v_mov_b32 v8, 0
    s_mov_b32 s31, 4
    s_and_b32 s41, s2, 7
    s_lshr_b32 s42, s2, 3
    s_and_b32 s29, s41, 3
    s_lshl_b32 s29, s29, 2
    s_and_b32 s43, s42, 3
    s_add_u32 s29, s29, s43
    s_lshr_b32 s41, s41, 2
    s_lshr_b32 s42, s42, 2
    s_lshl_b32 s30, s41, 3
    s_add_u32 s30, s30, s42
    s_cmp_ge_u32 s30, 15
    s_cbranch_scc1 L_ATT
    s_cmp_ge_u32 s30, 5
    s_cselect_b32 s31, 1, 0
    s_cmp_ge_u32 s30, 10
    s_cselect_b32 s31, 2, s31
    s_mov_b32 s38, 3840
    s_mov_b32 s40, 7680
    s_lshl_b32 s39, s30, 7
    v_lshlrev_b32 v4, 4, v1
    v_lshrrev_b32 v11, 4, v1
    v_lshlrev_b32 v5, 6, v11
    v_and_b32 v12, 3, v1
    v_lshlrev_b32 v12, 4, v12
    v_add_u32 v5, v5, v12
    v_bfe_u32 v12, v1, 2, 2
    v_mul_lo_u32 v12, v12, s38
    v_add_u32 v5, v5, v12
    s_cmp_eq_u32 s31, 3
    s_cselect_b32 s41, s30, 0
    s_cmp_eq_u32 s41, 13
    s_cselect_b32 s41, s101, 0
    v_cmp_le_u32 vcc, 2, v11
    v_mov_b32 v12, s41
    s_lshl_b32 s41, s38, 2
    s_sub_u32 s41, s41, 1024
    v_cndmask_b32 v12, 0, v12, vcc
    v_add_u32 v5, v5, v12
    v_add_u32 v6, s41, v5
    v_add_u32 v7, s41, v6
    v_add_u32 v8, s41, v7
    s_lshl_b32 s35, s38, 6
    s_lshl_b32 s41, s38, 4
    s_mul_i32 s41, s41, s100
    s_lshl_b32 s33, s39, 1
    s_add_u32 s33, s33, s41
    s_lshl_b32 s34, s100, 12
    s_mul_i32 s49, s38, 640
    s_mov_b32 s12, s50
    s_mov_b32 s13, s51
    s_mov_b32 s14, s49
    s_mov_b32 s15, 0x20000
    s_mov_b32 s36, 0
    s_mov_b32 s48, 0
    s_add_u32 m0, s36, s34
    s_add_u32 s36, s36, 16384
    s_cmp_eq_u32 s36, 98304
    s_cselect_b32 s36, 0, s36
    buffer_load_dwordx4 v5, s[12:15], s33 offen lds
    buffer_load_dwordx4 v6, s[12:15], s33 offen offset:1024 lds
    buffer_load_dwordx4 v7, s[12:15], s33 offen offset:2048 lds
    buffer_load_dwordx4 v8, s[12:15], s33 offen offset:3072 lds
    s_add_u32 s33, s33, s35
    s_add_u32 m0, s36, s34
    s_add_u32 s36, s36, 16384
    s_cmp_eq_u32 s36, 98304
    s_cselect_b32 s36, 0, s36
    buffer_load_dwordx4 v5, s[12:15], s33 offen lds
    buffer_load_dwordx4 v6, s[12:15], s33 offen offset:1024 lds
    buffer_load_dwordx4 v7, s[12:15], s33 offen offset:2048 lds
    buffer_load_dwordx4 v8, s[12:15], s33 offen offset:3072 lds
    s_add_u32 s33, s33, s35
    s_add_u32 m0, s36, s34
    s_add_u32 s36, s36, 16384
    s_cmp_eq_u32 s36, 98304
    s_cselect_b32 s36, 0, s36
    buffer_load_dwordx4 v5, s[12:15], s33 offen lds
    buffer_load_dwordx4 v6, s[12:15], s33 offen offset:1024 lds
    buffer_load_dwordx4 v7, s[12:15], s33 offen offset:2048 lds
    buffer_load_dwordx4 v8, s[12:15], s33 offen offset:3072 lds
    s_add_u32 s33, s33, s35
    s_add_u32 m0, s36, s34
    s_add_u32 s36, s36, 16384
    s_cmp_eq_u32 s36, 98304
    s_cselect_b32 s36, 0, s36
    buffer_load_dwordx4 v5, s[12:15], s33 offen lds
    buffer_load_dwordx4 v6, s[12:15], s33 offen offset:1024 lds
    buffer_load_dwordx4 v7, s[12:15], s33 offen offset:2048 lds
    buffer_load_dwordx4 v8, s[12:15], s33 offen offset:3072 lds
    s_add_u32 s33, s33, s35
    s_add_u32 m0, s36, s34
    s_add_u32 s36, s36, 16384
    s_cmp_eq_u32 s36, 98304
    s_cselect_b32 s36, 0, s36
    buffer_load_dwordx4 v5, s[12:15], s33 offen lds
    buffer_load_dwordx4 v6, s[12:15], s33 offen offset:1024 lds
    buffer_load_dwordx4 v7, s[12:15], s33 offen offset:2048 lds
    buffer_load_dwordx4 v8, s[12:15], s33 offen offset:3072 lds
    s_add_u32 s33, s33, s35
    s_add_u32 m0, s36, s34
    s_add_u32 s36, s36, 16384
    s_cmp_eq_u32 s36, 98304
    s_cselect_b32 s36, 0, s36
    buffer_load_dwordx4 v5, s[12:15], s33 offen lds
    buffer_load_dwordx4 v6, s[12:15], s33 offen offset:1024 lds
    buffer_load_dwordx4 v7, s[12:15], s33 offen offset:2048 lds
    buffer_load_dwordx4 v8, s[12:15], s33 offen offset:3072 lds
    s_add_u32 s33, s33, s35
L_WIDE:
    s_cmp_eq_u32 s31, 3
    s_cselect_b32 s41, 1, 0
    s_lshl_b32 s42, s7, 1
    s_add_u32 s41, s41, s42
    s_mul_i32 s41, s41, 2621440
    s_add_u32 s8, s4, s41
    s_addc_u32 s9, s5, 0
    s_mov_b32 s10, 2621440
    s_mov_b32 s11, 0x20000
    s_lshl_b32 s41, s29, 2
    s_add_u32 s41, s41, s100
    s_mul_i32 s32, s41, 40960
    s_cmp_eq_u32 s31, 3
    s_cselect_b32 s41, 1, 0
    s_lshl_b32 s42, s7, 1
    s_add_u32 s41, s41, s42
    s_lshl_b32 s41, s41, 18
    s_add_u32 s41, s41, 0xa00000
    s_add_u32 s16, s4, s41
    s_addc_u32 s17, s5, 0
    s_mov_b32 s18, 262144
    s_mov_b32 s19, 0x20000
    s_mov_b32 s41, 0xb00000
    s_mov_b32 s42, 30720
    s_cmp_eq_u32 s31, 3
    s_cselect_b32 s41, 0xb08000, s41
    s_cselect_b32 s42, 27648, s42
    s_add_u32 s20, s4, s41
    s_addc_u32 s21, s5, 0
    s_mov_b32 s22, s42
    s_mov_b32 s23, 0x20000
    s_lshl_b32 s52, s29, 2
    s_add_u32 s52, s52, s100
    s_lshl_b32 s52, s52, 12
    s_lshl_b32 s53, s40, 1
    s_add_u32 s54, s53, s40
    v_lshlrev_b32 v44, 4, v3
    v_lshl_add_u32 v44, v2, 11, v44
    v_and_b32 v45, 127, v0
    v_add_u32 v45, s39, v45
    v_lshlrev_b32 v45, 2, v45
    s_barrier
    s_add_u32 s41, s48, s34
    s_add_u32 m0, s41, 98304
    s_add_u32 s48, s48, 16384
    s_cmp_eq_u32 s48, 49152
    s_cselect_b32 s48, 0, s48
    buffer_load_dwordx4 v4, s[8:11], s32 offen lds
    buffer_load_dwordx4 v4, s[8:11], s32 offen offset:1024 lds
    buffer_load_dwordx4 v4, s[8:11], s32 offen offset:2048 lds
    buffer_load_dwordx4 v4, s[8:11], s32 offen offset:3072 lds
    s_add_u32 s32, s32, 4096
    s_add_u32 s41, s48, s34
    s_add_u32 m0, s41, 98304
    s_add_u32 s48, s48, 16384
    s_cmp_eq_u32 s48, 49152
    s_cselect_b32 s48, 0, s48
    buffer_load_dwordx4 v4, s[8:11], s32 offen lds
    buffer_load_dwordx4 v4, s[8:11], s32 offen offset:1024 lds
    buffer_load_dwordx4 v4, s[8:11], s32 offen offset:2048 lds
    buffer_load_dwordx4 v4, s[8:11], s32 offen offset:3072 lds
    s_add_u32 s32, s32, 4096
    s_waitcnt vmcnt(4)
    s_barrier
    s_add_u32 s41, s48, s34
    s_add_u32 m0, s41, 98304
    s_add_u32 s48, s48, 16384
    s_cmp_eq_u32 s48, 49152
    s_cselect_b32 s48, 0, s48
    buffer_load_dwordx4 v4, s[8:11], s32 offen lds
    buffer_load_dwordx4 v4, s[8:11], s32 offen offset:1024 lds
    buffer_load_dwordx4 v4, s[8:11], s32 offen offset:2048 lds
    buffer_load_dwordx4 v4, s[8:11], s32 offen offset:3072 lds
    s_add_u32 s32, s32, 4096
    s_waitcnt vmcnt(4)
    s_barrier
    s_add_u32 s41, s48, s34
    s_add_u32 m0, s41, 98304
    s_add_u32 s48, s48, 16384
    s_cmp_eq_u32 s48, 49152
    s_cselect_b32 s48, 0, s48
    buffer_load_dwordx4 v4, s[8:11], s32 offen lds
    buffer_load_dwordx4 v4, s[8:11], s32 offen offset:1024 lds
    buffer_load_dwordx4 v4, s[8:11], s32 offen offset:2048 lds
    buffer_load_dwordx4 v4, s[8:11], s32 offen offset:3072 lds
    s_add_u32 s32, s32, 4096
    s_add_u32 m0, s36, s34
    s_add_u32 s36, s36, 16384
    s_cmp_eq_u32 s36, 98304
    s_cselect_b32 s36, 0, s36
    buffer_load_dwordx4 v5, s[12:15], s33 offen lds
    buffer_load_dwordx4 v6, s[12:15], s33 offen offset:1024 lds
    buffer_load_dwordx4 v7, s[12:15], s33 offen offset:2048 lds
    buffer_load_dwordx4 v8, s[12:15], s33 offen offset:3072 lds
    s_add_u32 s33, s33, s35
    s_waitcnt vmcnt(8)
    s_barrier
    s_mov_b32 s37, 3
L_lw_0:
    s_add_u32 s41, s48, s34
    s_add_u32 m0, s41, 98304
    s_add_u32 s48, s48, 16384
    s_cmp_eq_u32 s48, 49152
    s_cselect_b32 s48, 0, s48
    buffer_load_dwordx4 v4, s[8:11], s32 offen lds
    buffer_load_dwordx4 v4, s[8:11], s32 offen offset:1024 lds
    buffer_load_dwordx4 v4, s[8:11], s32 offen offset:2048 lds
    buffer_load_dwordx4 v4, s[8:11], s32 offen offset:3072 lds
    s_add_u32 s32, s32, 4096
    s_add_u32 m0, s36, s34
    s_add_u32 s36, s36, 16384
    s_cmp_eq_u32 s36, 98304
    s_cselect_b32 s36, 0, s36
    buffer_load_dwordx4 v5, s[12:15], s33 offen lds
    buffer_load_dwordx4 v6, s[12:15], s33 offen offset:1024 lds
    buffer_load_dwordx4 v7, s[12:15], s33 offen offset:2048 lds
    buffer_load_dwordx4 v8, s[12:15], s33 offen offset:3072 lds
    s_add_u32 s33, s33, s35
    s_waitcnt vmcnt(12)
    s_barrier
    s_sub_u32 s37, s37, 1
    s_cmp_lg_u32 s37, 0
    s_cbranch_scc1 L_lw_0
    s_add_u32 s41, s48, s34
    s_add_u32 m0, s41, 98304
    s_add_u32 s48, s48, 16384
    s_cmp_eq_u32 s48, 49152
    s_cselect_b32 s48, 0, s48
    buffer_load_dwordx4 v4, s[8:11], s32 offen lds
    buffer_load_dwordx4 v4, s[8:11], s32 offen offset:1024 lds
    buffer_load_dwordx4 v4, s[8:11], s32 offen offset:2048 lds
    buffer_load_dwordx4 v4, s[8:11], s32 offen offset:3072 lds
    s_add_u32 s32, s32, 4096
    buffer_load_dwordx4 v[24:27], v44, s[16:19], s52 offen
    buffer_load_dwordx4 v[28:31], v44, s[16:19], s52 offen offset:512
    buffer_load_dwordx4 v[32:35], v44, s[16:19], s52 offen offset:1024
    buffer_load_dwordx4 v[36:39], v44, s[16:19], s52 offen offset:1536
    buffer_load_dword v40, v45, s[20:23], 0 offen
    buffer_load_dword v41, v45, s[20:23], s40 offen
    buffer_load_dword v42, v45, s[20:23], s53 offen
    buffer_load_dword v43, v45, s[20:23], s54 offen
    s_waitcnt vmcnt(16)
    s_barrier
    s_add_u32 s41, s48, s34
    s_add_u32 m0, s41, 98304
    s_add_u32 s48, s48, 16384
    s_cmp_eq_u32 s48, 49152
    s_cselect_b32 s48, 0, s48
    buffer_load_dwordx4 v4, s[8:11], s32 offen lds
    buffer_load_dwordx4 v4, s[8:11], s32 offen offset:1024 lds
    buffer_load_dwordx4 v4, s[8:11], s32 offen offset:2048 lds
    buffer_load_dwordx4 v4, s[8:11], s32 offen offset:3072 lds
    s_add_u32 s32, s32, 4096
    s_waitcnt vmcnt(12)
    s_barrier
    s_add_u32 s41, s48, s34
    s_add_u32 m0, s41, 98304
    s_add_u32 s48, s48, 16384
    s_cmp_eq_u32 s48, 49152
    s_cselect_b32 s48, 0, s48
    buffer_load_dwordx4 v4, s[8:11], s32 offen lds
    buffer_load_dwordx4 v4, s[8:11], s32 offen offset:1024 lds
    buffer_load_dwordx4 v4, s[8:11], s32 offen offset:2048 lds
    buffer_load_dwordx4 v4, s[8:11], s32 offen offset:3072 lds
    s_add_u32 s32, s32, 4096
    s_waitcnt vmcnt(4)
    v_pk_add_f32 v[24:25], v[24:25], v[26:27]
    v_pk_add_f32 v[28:29], v[28:29], v[30:31]
    v_pk_add_f32 v[32:33], v[32:33], v[34:35]
    v_pk_add_f32 v[36:37], v[36:37], v[38:39]
    v_pk_add_f32 v[24:25], v[24:25], v[28:29]
    v_pk_add_f32 v[32:33], v[32:33], v[36:37]
    v_add_f32 v40, v40, v41
    v_add_f32 v42, v42, v43
    v_pk_add_f32 v[24:25], v[24:25], v[32:33]
    v_add_f32 v40, v40, v42
    v_mov_b32 v46, v24
    s_nop 1
    v_permlane32_swap_b32 v24, v46
    v_add_f32 v24, v24, v46
    v_mov_b32 v47, v25
    s_nop 1
    v_permlane32_swap_b32 v25, v47
    v_add_f32 v25, v25, v47
    v_mul_f32 v24, 0x3acccccd, v24
    v_mul_f32 v25, 0x3acccccd, v25
    v_fma_f32 v25, -v24, v24, v25
    v_max_f32 v25, 0, v25
    v_add_f32 v27, 0x3727c5ac, v25
    v_rsq_f32 v25, v27
    v_sub_f32 v28, 0, v24
    s_lshl_b32 s41, s100, 7
    s_add_u32 s41, s41, 147968
    v_lshlrev_b32 v46, 2, v3
    v_add_u32 v46, s41, v46
    v_mul_f32 v27, v27, v25
    v_mul_f32 v26, v24, v25
    v_and_b32 v47, 127, v0
    v_lshlrev_b32 v47, 2, v47
    v_add_u32 v47, 147456, v47
    ds_write_b32 v46, v25
    ds_write_b32 v46, v26 offset:512
    ds_write_b32 v46, v28 offset:1024
    ds_write_b32 v46, v27 offset:1536
    ds_write_b32 v47, v40
    s_waitcnt lgkmcnt(0)
    s_barrier
    s_waitcnt vmcnt(0)
    s_barrier
    s_barrier
    s_cmp_eq_u32 s31, 3
    s_cbranch_scc1 L_wide_fa_end
    s_barrier
    s_branch L_ATT
L_wide_fa_end:
    s_and_b32 s37, s2, 7
    s_lshr_b32 s38, s2, 3
    s_and_b32 s29, s37, 3
    s_lshl_b32 s29, s29, 3
    s_and_b32 s39, s38, 7
    s_add_u32 s29, s29, s39
    s_lshr_b32 s37, s37, 2
    s_lshl_b32 s37, s37, 2
    s_lshr_b32 s38, s38, 3
    s_add_u32 s30, s37, s38
    s_mov_b32 s55, 27
    s_mov_b32 s45, 108
    v_lshlrev_b32 v4, 4, v1
    s_mov_b32 s37, 0xb40000
    s_mov_b32 s38, 819200
    s_cmp_eq_u32 s55, 27
    s_cselect_b32 s37, 0xc40000, s37
    s_cselect_b32 s38, 2211840, s38
    s_add_u32 s12, s4, s37
    s_addc_u32 s13, s5, 0
    s_mov_b32 s14, s38
    s_mov_b32 s15, 0x20000
    s_mul_i32 s37, s100, 3072
    s_cmp_eq_u32 s100, 3
    s_cselect_b32 s37, 8192, s37
    s_add_u32 s44, s37, 49152
    s_lshl_b32 s38, s45, 2
    s_mul_i32 s38, s38, 640
    s_mul_i32 s38, s38, s30
    s_add_u32 s33, s38, s37
    s_mov_b32 s34, 0
    s_mov_b32 s56, 0
    s_and_b32 s40, s100, 1
    s_lshr_b32 s41, s100, 1
    s_lshl_b32 s43, s40, 12
    s_lshl_b32 s38, s41, 11
    s_add_u32 s43, s43, s38
    s_cmp_lt_u32 s100, 2
    s_cbranch_scc0 L_lnpfs_fb_3
    s_mov_b32 s36, 3
L_lnpf_fb_3:
    s_add_u32 m0, s34, s44
    s_add_u32 s34, s34, 10240
    s_cmp_eq_u32 s34, 102400
    s_cselect_b32 s34, 0, s34
    buffer_load_dwordx4 v4, s[12:15], s33 offen lds
    buffer_load_dwordx4 v4, s[12:15], s33 offen offset:1024 lds
    buffer_load_dwordx4 v4, s[12:15], s33 offen offset:2048 lds
    s_add_u32 s33, s33, 10240
    s_sub_u32 s36, s36, 1
    s_cmp_lg_u32 s36, 0
    s_cbranch_scc1 L_lnpf_fb_3
L_lnpfs_fb_3:
    s_cmp_lt_u32 s100, 2
    s_cbranch_scc1 L_lnpfs_fb_2
    s_mov_b32 s36, 3
L_lnpf_fb_2:
    s_add_u32 m0, s34, s44
    s_add_u32 s34, s34, 10240
    s_cmp_eq_u32 s34, 102400
    s_cselect_b32 s34, 0, s34
    buffer_load_dwordx4 v4, s[12:15], s33 offen lds
    buffer_load_dwordx4 v4, s[12:15], s33 offen offset:1024 lds
    s_add_u32 s33, s33, 10240
    s_sub_u32 s36, s36, 1
    s_cmp_lg_u32 s36, 0
    s_cbranch_scc1 L_lnpf_fb_2
L_lnpfs_fb_2:
    s_barrier
    s_cmp_lt_u32 s100, 2
    s_cbranch_scc0 L_lnpfs_fbb_3
    s_mov_b32 s36, 7
L_lnpf_fbb_3:
    s_add_u32 m0, s34, s44
    s_add_u32 s34, s34, 10240
    s_cmp_eq_u32 s34, 102400
    s_cselect_b32 s34, 0, s34
    buffer_load_dwordx4 v4, s[12:15], s33 offen lds
    buffer_load_dwordx4 v4, s[12:15], s33 offen offset:1024 lds
    buffer_load_dwordx4 v4, s[12:15], s33 offen offset:2048 lds
    s_add_u32 s33, s33, 10240
    s_sub_u32 s36, s36, 1
    s_cmp_lg_u32 s36, 0
    s_cbranch_scc1 L_lnpf_fbb_3
L_lnpfs_fbb_3:
    s_cmp_lt_u32 s100, 2
    s_cbranch_scc1 L_lnpfs_fbb_2
    s_mov_b32 s36, 7
L_lnpf_fbb_2:
    s_add_u32 m0, s34, s44
    s_add_u32 s34, s34, 10240
    s_cmp_eq_u32 s34, 102400
    s_cselect_b32 s34, 0, s34
    buffer_load_dwordx4 v4, s[12:15], s33 offen lds
    buffer_load_dwordx4 v4, s[12:15], s33 offen offset:1024 lds
    s_add_u32 s33, s33, 10240
    s_sub_u32 s36, s36, 1
    s_cmp_lg_u32 s36, 0
    s_cbranch_scc1 L_lnpf_fbb_2
L_lnpfs_fbb_2:
    s_branch L_NARROW
L_ATT:
    s_barrier
    s_and_b32 s37, s2, 7
    s_lshr_b32 s38, s2, 3
    s_and_b32 s29, s37, 3
    s_lshl_b32 s29, s29, 3
    s_and_b32 s39, s38, 7
    s_add_u32 s29, s29, s39
    s_lshr_b32 s37, s37, 2
    s_lshl_b32 s37, s37, 2
    s_lshr_b32 s38, s38, 3
    s_add_u32 s30, s37, s38
    s_mov_b32 s55, 10
    s_mov_b32 s45, 40
    v_lshlrev_b32 v4, 4, v1
    s_mov_b32 s37, 0xb40000
    s_mov_b32 s38, 819200
    s_cmp_eq_u32 s55, 27
    s_cselect_b32 s37, 0xc40000, s37
    s_cselect_b32 s38, 2211840, s38
    s_add_u32 s12, s4, s37
    s_addc_u32 s13, s5, 0
    s_mov_b32 s14, s38
    s_mov_b32 s15, 0x20000
    s_mul_i32 s37, s100, 3072
    s_cmp_eq_u32 s100, 3
    s_cselect_b32 s37, 8192, s37
    s_add_u32 s44, s37, 49152
    s_lshl_b32 s38, s45, 2
    s_mul_i32 s38, s38, 640
    s_mul_i32 s38, s38, s30
    s_add_u32 s33, s38, s37
    s_mov_b32 s34, 0
    s_mov_b32 s56, 0
    s_and_b32 s40, s100, 1
    s_lshr_b32 s41, s100, 1
    s_lshl_b32 s43, s40, 12
    s_lshl_b32 s38, s41, 11
    s_add_u32 s43, s43, s38
    s_barrier
    s_cmp_lt_u32 s100, 2
    s_cbranch_scc0 L_lnpfs_o_3
    s_mov_b32 s36, 3
L_lnpf_o_3:
    s_add_u32 m0, s34, s44
    s_add_u32 s34, s34, 10240
    s_cmp_eq_u32 s34, 102400
    s_cselect_b32 s34, 0, s34
    buffer_load_dwordx4 v4, s[12:15], s33 offen lds
    buffer_load_dwordx4 v4, s[12:15], s33 offen offset:1024 lds
    buffer_load_dwordx4 v4, s[12:15], s33 offen offset:2048 lds
    s_add_u32 s33, s33, 10240
    s_sub_u32 s36, s36, 1
    s_cmp_lg_u32 s36, 0
    s_cbranch_scc1 L_lnpf_o_3
L_lnpfs_o_3:
    s_cmp_lt_u32 s100, 2
    s_cbranch_scc1 L_lnpfs_o_2
    s_mov_b32 s36, 3
L_lnpf_o_2:
    s_add_u32 m0, s34, s44
    s_add_u32 s34, s34, 10240
    s_cmp_eq_u32 s34, 102400
    s_cselect_b32 s34, 0, s34
    buffer_load_dwordx4 v4, s[12:15], s33 offen lds
    buffer_load_dwordx4 v4, s[12:15], s33 offen offset:1024 lds
    s_add_u32 s33, s33, 10240
    s_sub_u32 s36, s36, 1
    s_cmp_lg_u32 s36, 0
    s_cbranch_scc1 L_lnpf_o_2
L_lnpfs_o_2:
    s_barrier
    s_cmp_lt_u32 s100, 2
    s_cbranch_scc0 L_lnpfs_ob_3
    s_mov_b32 s36, 7
L_lnpf_ob_3:
    s_add_u32 m0, s34, s44
    s_add_u32 s34, s34, 10240
    s_cmp_eq_u32 s34, 102400
    s_cselect_b32 s34, 0, s34
    buffer_load_dwordx4 v4, s[12:15], s33 offen lds
    buffer_load_dwordx4 v4, s[12:15], s33 offen offset:1024 lds
    buffer_load_dwordx4 v4, s[12:15], s33 offen offset:2048 lds
    s_add_u32 s33, s33, 10240
    s_sub_u32 s36, s36, 1
    s_cmp_lg_u32 s36, 0
    s_cbranch_scc1 L_lnpf_ob_3
L_lnpfs_ob_3:
    s_cmp_lt_u32 s100, 2
    s_cbranch_scc1 L_lnpfs_ob_2
    s_mov_b32 s36, 7
L_lnpf_ob_2:
    s_add_u32 m0, s34, s44
    s_add_u32 s34, s34, 10240
    s_cmp_eq_u32 s34, 102400
    s_cselect_b32 s34, 0, s34
    buffer_load_dwordx4 v4, s[12:15], s33 offen lds
    buffer_load_dwordx4 v4, s[12:15], s33 offen offset:1024 lds
    s_add_u32 s33, s33, 10240
    s_sub_u32 s36, s36, 1
    s_cmp_lg_u32 s36, 0
    s_cbranch_scc1 L_lnpf_ob_2
L_lnpfs_ob_2:
L_NARROW:
    s_mov_b32 s37, 0x1800000
    s_mov_b32 s38, 2621440
    s_cmp_eq_u32 s55, 27
    s_cselect_b32 s37, 0x1a80000, s37
    s_cselect_b32 s38, 7077888, s38
    s_mul_i32 s39, s7, 0x1400000
    s_add_u32 s37, s37, s39
    s_add_u32 s8, s4, s37
    s_addc_u32 s9, s5, 0
    s_mov_b32 s10, s38
    s_mov_b32 s11, 0x20000
    s_lshl_b32 s37, s29, 1
    s_add_u32 s37, s37, s40
    s_mul_i32 s37, s37, s45
    s_lshl_b32 s38, s41, 1
    s_add_u32 s37, s37, s38
    s_lshl_b32 s32, s37, 10
    s_barrier
    s_cmp_lt_u32 s100, 2
    s_cbranch_scc0 L_ln_next_3_10
    s_cmp_eq_u32 s55, 10
    s_cbranch_scc0 L_ln_next_3_10
    s_add_u32 m0, s56, s43
    s_add_u32 s56, s56, 8192
    s_cmp_eq_u32 s56, 49152
    s_cselect_b32 s56, 0, s56
    buffer_load_dwordx4 v4, s[8:11], s32 offen lds
    buffer_load_dwordx4 v4, s[8:11], s32 offen offset:1024 lds
    s_add_u32 s32, s32, 4096
    s_add_u32 m0, s56, s43
    s_add_u32 s56, s56, 8192
    s_cmp_eq_u32 s56, 49152
    s_cselect_b32 s56, 0, s56
    buffer_load_dwordx4 v4, s[8:11], s32 offen lds
    buffer_load_dwordx4 v4, s[8:11], s32 offen offset:1024 lds
    s_add_u32 s32, s32, 4096
    s_add_u32 m0, s56, s43
    s_add_u32 s56, s56, 8192
    s_cmp_eq_u32 s56, 49152
    s_cselect_b32 s56, 0, s56
    buffer_load_dwordx4 v4, s[8:11], s32 offen lds
    buffer_load_dwordx4 v4, s[8:11], s32 offen offset:1024 lds
    s_add_u32 s32, s32, 4096
    s_add_u32 m0, s56, s43
    s_add_u32 s56, s56, 8192
    s_cmp_eq_u32 s56, 49152
    s_cselect_b32 s56, 0, s56
    buffer_load_dwordx4 v4, s[8:11], s32 offen lds
    buffer_load_dwordx4 v4, s[8:11], s32 offen offset:1024 lds
    s_add_u32 s32, s32, 4096
    s_waitcnt vmcnt(6)
    s_barrier
    s_add_u32 m0, s56, s43
    s_add_u32 s56, s56, 8192
    s_cmp_eq_u32 s56, 49152
    s_cselect_b32 s56, 0, s56
    buffer_load_dwordx4 v4, s[8:11], s32 offen lds
    buffer_load_dwordx4 v4, s[8:11], s32 offen offset:1024 lds
    s_add_u32 s32, s32, 4096
    s_add_u32 m0, s56, s43
    s_add_u32 s56, s56, 8192
    s_cmp_eq_u32 s56, 49152
    s_cselect_b32 s56, 0, s56
    buffer_load_dwordx4 v4, s[8:11], s32 offen lds
    buffer_load_dwordx4 v4, s[8:11], s32 offen offset:1024 lds
    s_add_u32 s32, s32, 4096
    s_waitcnt vmcnt(8)
    s_barrier
    s_mov_b32 s36, 4
L_ln3_10_0:
    s_add_u32 m0, s56, s43
    s_add_u32 s56, s56, 8192
    s_cmp_eq_u32 s56, 49152
    s_cselect_b32 s56, 0, s56
    buffer_load_dwordx4 v4, s[8:11], s32 offen lds
    buffer_load_dwordx4 v4, s[8:11], s32 offen offset:1024 lds
    s_add_u32 s32, s32, 4096
    s_waitcnt vmcnt(8)
    s_barrier
    s_sub_u32 s36, s36, 1
    s_cmp_lg_u32 s36, 0
    s_cbranch_scc1 L_ln3_10_0
    s_waitcnt vmcnt(6)
    s_barrier
    s_waitcnt vmcnt(4)
    s_barrier
    s_waitcnt vmcnt(2)
    s_barrier
    s_waitcnt vmcnt(0)
    s_barrier
    s_branch L_ln_done
L_ln_next_3_10:
    s_cmp_lt_u32 s100, 2
    s_cbranch_scc0 L_ln_next_3_27
    s_cmp_eq_u32 s55, 27
    s_cbranch_scc0 L_ln_next_3_27
    s_add_u32 m0, s56, s43
    s_add_u32 s56, s56, 8192
    s_cmp_eq_u32 s56, 49152
    s_cselect_b32 s56, 0, s56
    buffer_load_dwordx4 v4, s[8:11], s32 offen lds
    buffer_load_dwordx4 v4, s[8:11], s32 offen offset:1024 lds
    s_add_u32 s32, s32, 4096
    s_add_u32 m0, s56, s43
    s_add_u32 s56, s56, 8192
    s_cmp_eq_u32 s56, 49152
    s_cselect_b32 s56, 0, s56
    buffer_load_dwordx4 v4, s[8:11], s32 offen lds
    buffer_load_dwordx4 v4, s[8:11], s32 offen offset:1024 lds
    s_add_u32 s32, s32, 4096
    s_add_u32 m0, s56, s43
    s_add_u32 s56, s56, 8192
    s_cmp_eq_u32 s56, 49152
    s_cselect_b32 s56, 0, s56
    buffer_load_dwordx4 v4, s[8:11], s32 offen lds
    buffer_load_dwordx4 v4, s[8:11], s32 offen offset:1024 lds
    s_add_u32 s32, s32, 4096
    s_add_u32 m0, s56, s43
    s_add_u32 s56, s56, 8192
    s_cmp_eq_u32 s56, 49152
    s_cselect_b32 s56, 0, s56
    buffer_load_dwordx4 v4, s[8:11], s32 offen lds
    buffer_load_dwordx4 v4, s[8:11], s32 offen offset:1024 lds
    s_add_u32 s32, s32, 4096
    s_waitcnt vmcnt(6)
    s_barrier
    s_add_u32 m0, s56, s43
    s_add_u32 s56, s56, 8192
    s_cmp_eq_u32 s56, 49152
    s_cselect_b32 s56, 0, s56
    buffer_load_dwordx4 v4, s[8:11], s32 offen lds
    buffer_load_dwordx4 v4, s[8:11], s32 offen offset:1024 lds
    s_add_u32 s32, s32, 4096
    s_add_u32 m0, s56, s43
    s_add_u32 s56, s56, 8192
    s_cmp_eq_u32 s56, 49152
    s_cselect_b32 s56, 0, s56
    buffer_load_dwordx4 v4, s[8:11], s32 offen lds
    buffer_load_dwordx4 v4, s[8:11], s32 offen offset:1024 lds
    s_add_u32 s32, s32, 4096
    s_waitcnt vmcnt(8)
    s_barrier
    s_add_u32 m0, s56, s43
    s_add_u32 s56, s56, 8192
    s_cmp_eq_u32 s56, 49152
    s_cselect_b32 s56, 0, s56
    buffer_load_dwordx4 v4, s[8:11], s32 offen lds
    buffer_load_dwordx4 v4, s[8:11], s32 offen offset:1024 lds
    s_add_u32 s32, s32, 4096
    s_add_u32 m0, s34, s44
    s_add_u32 s34, s34, 10240
    s_cmp_eq_u32 s34, 102400
    s_cselect_b32 s34, 0, s34
    buffer_load_dwordx4 v4, s[12:15], s33 offen lds
    buffer_load_dwordx4 v4, s[12:15], s33 offen offset:1024 lds
    buffer_load_dwordx4 v4, s[12:15], s33 offen offset:2048 lds
    s_add_u32 s33, s33, 10240
    s_waitcnt vmcnt(11)
    s_barrier
    s_add_u32 m0, s56, s43
    s_add_u32 s56, s56, 8192
    s_cmp_eq_u32 s56, 49152
    s_cselect_b32 s56, 0, s56
    buffer_load_dwordx4 v4, s[8:11], s32 offen lds
    buffer_load_dwordx4 v4, s[8:11], s32 offen offset:1024 lds
    s_add_u32 s32, s32, 4096
    s_add_u32 m0, s34, s44
    s_add_u32 s34, s34, 10240
    s_cmp_eq_u32 s34, 102400
    s_cselect_b32 s34, 0, s34
    buffer_load_dwordx4 v4, s[12:15], s33 offen lds
    buffer_load_dwordx4 v4, s[12:15], s33 offen offset:1024 lds
    buffer_load_dwordx4 v4, s[12:15], s33 offen offset:2048 lds
    s_add_u32 s33, s33, 10240
    s_waitcnt vmcnt(14)
    s_barrier
    s_add_u32 m0, s56, s43
    s_add_u32 s56, s56, 8192
    s_cmp_eq_u32 s56, 49152
    s_cselect_b32 s56, 0, s56
    buffer_load_dwordx4 v4, s[8:11], s32 offen lds
    buffer_load_dwordx4 v4, s[8:11], s32 offen offset:1024 lds
    s_add_u32 s32, s32, 4096
    s_add_u32 m0, s34, s44
    s_add_u32 s34, s34, 10240
    s_cmp_eq_u32 s34, 102400
    s_cselect_b32 s34, 0, s34
    buffer_load_dwordx4 v4, s[12:15], s33 offen lds
    buffer_load_dwordx4 v4, s[12:15], s33 offen offset:1024 lds
    buffer_load_dwordx4 v4, s[12:15], s33 offen offset:2048 lds
    s_add_u32 s33, s33, 10240
    s_waitcnt vmcnt(17)
    s_barrier
    s_add_u32 m0, s56, s43
    s_add_u32 s56, s56, 8192
    s_cmp_eq_u32 s56, 49152
    s_cselect_b32 s56, 0, s56
    buffer_load_dwordx4 v4, s[8:11], s32 offen lds
    buffer_load_dwordx4 v4, s[8:11], s32 offen offset:1024 lds
    s_add_u32 s32, s32, 4096
    s_add_u32 m0, s34, s44
    s_add_u32 s34, s34, 10240
    s_cmp_eq_u32 s34, 102400
    s_cselect_b32 s34, 0, s34
    buffer_load_dwordx4 v4, s[12:15], s33 offen lds
    buffer_load_dwordx4 v4, s[12:15], s33 offen offset:1024 lds
    buffer_load_dwordx4 v4, s[12:15], s33 offen offset:2048 lds
    s_add_u32 s33, s33, 10240
    s_waitcnt vmcnt(20)
    s_barrier
    s_mov_b32 s36, 13
L_ln3_27_0:
    s_add_u32 m0, s56, s43
    s_add_u32 s56, s56, 8192
    s_cmp_eq_u32 s56, 49152
    s_cselect_b32 s56, 0, s56
    buffer_load_dwordx4 v4, s[8:11], s32 offen lds
    buffer_load_dwordx4 v4, s[8:11], s32 offen offset:1024 lds
    s_add_u32 s32, s32, 4096
    s_add_u32 m0, s34, s44
    s_add_u32 s34, s34, 10240
    s_cmp_eq_u32 s34, 102400
    s_cselect_b32 s34, 0, s34
    buffer_load_dwordx4 v4, s[12:15], s33 offen lds
    buffer_load_dwordx4 v4, s[12:15], s33 offen offset:1024 lds
    buffer_load_dwordx4 v4, s[12:15], s33 offen offset:2048 lds
    s_add_u32 s33, s33, 10240
    s_waitcnt vmcnt(23)
    s_barrier
    s_sub_u32 s36, s36, 1
    s_cmp_lg_u32 s36, 0
    s_cbranch_scc1 L_ln3_27_0
    s_add_u32 m0, s56, s43
    s_add_u32 s56, s56, 8192
    s_cmp_eq_u32 s56, 49152
    s_cselect_b32 s56, 0, s56
    buffer_load_dwordx4 v4, s[8:11], s32 offen lds
    buffer_load_dwordx4 v4, s[8:11], s32 offen offset:1024 lds
    s_add_u32 s32, s32, 4096
    s_waitcnt vmcnt(20)
    s_barrier
    s_add_u32 m0, s56, s43
    s_add_u32 s56, s56, 8192
    s_cmp_eq_u32 s56, 49152
    s_cselect_b32 s56, 0, s56
    buffer_load_dwordx4 v4, s[8:11], s32 offen lds
    buffer_load_dwordx4 v4, s[8:11], s32 offen offset:1024 lds
    s_add_u32 s32, s32, 4096
    s_waitcnt vmcnt(17)
    s_barrier
    s_add_u32 m0, s56, s43
    s_add_u32 s56, s56, 8192
    s_cmp_eq_u32 s56, 49152
    s_cselect_b32 s56, 0, s56
    buffer_load_dwordx4 v4, s[8:11], s32 offen lds
    buffer_load_dwordx4 v4, s[8:11], s32 offen offset:1024 lds
    s_add_u32 s32, s32, 4096
    s_waitcnt vmcnt(14)
    s_barrier
    s_add_u32 m0, s56, s43
    s_add_u32 s56, s56, 8192
    s_cmp_eq_u32 s56, 49152
    s_cselect_b32 s56, 0, s56
    buffer_load_dwordx4 v4, s[8:11], s32 offen lds
    buffer_load_dwordx4 v4, s[8:11], s32 offen offset:1024 lds
    s_add_u32 s32, s32, 4096
    s_waitcnt vmcnt(11)
    s_barrier
    s_waitcnt vmcnt(6)
    s_barrier
    s_waitcnt vmcnt(4)
    s_barrier
    s_waitcnt vmcnt(2)
    s_barrier
    s_waitcnt vmcnt(0)
    s_barrier
    s_branch L_ln_done
L_ln_next_3_27:
    s_cmp_lt_u32 s100, 2
    s_cbranch_scc1 L_ln_next_2_10
    s_cmp_eq_u32 s55, 10
    s_cbranch_scc0 L_ln_next_2_10
    s_add_u32 m0, s56, s43
    s_add_u32 s56, s56, 8192
    s_cmp_eq_u32 s56, 49152
    s_cselect_b32 s56, 0, s56
    buffer_load_dwordx4 v4, s[8:11], s32 offen lds
    buffer_load_dwordx4 v4, s[8:11], s32 offen offset:1024 lds
    s_add_u32 s32, s32, 4096
    s_add_u32 m0, s56, s43
    s_add_u32 s56, s56, 8192
    s_cmp_eq_u32 s56, 49152
    s_cselect_b32 s56, 0, s56
    buffer_load_dwordx4 v4, s[8:11], s32 offen lds
    buffer_load_dwordx4 v4, s[8:11], s32 offen offset:1024 lds
    s_add_u32 s32, s32, 4096
    s_add_u32 m0, s56, s43
    s_add_u32 s56, s56, 8192
    s_cmp_eq_u32 s56, 49152
    s_cselect_b32 s56, 0, s56
    buffer_load_dwordx4 v4, s[8:11], s32 offen lds
    buffer_load_dwordx4 v4, s[8:11], s32 offen offset:1024 lds
    s_add_u32 s32, s32, 4096
    s_add_u32 m0, s56, s43
    s_add_u32 s56, s56, 8192
    s_cmp_eq_u32 s56, 49152
    s_cselect_b32 s56, 0, s56
    buffer_load_dwordx4 v4, s[8:11], s32 offen lds
    buffer_load_dwordx4 v4, s[8:11], s32 offen offset:1024 lds
    s_add_u32 s32, s32, 4096
    s_waitcnt vmcnt(6)
    s_barrier
    s_add_u32 m0, s56, s43
    s_add_u32 s56, s56, 8192
    s_cmp_eq_u32 s56, 49152
    s_cselect_b32 s56, 0, s56
    buffer_load_dwordx4 v4, s[8:11], s32 offen lds
    buffer_load_dwordx4 v4, s[8:11], s32 offen offset:1024 lds
    s_add_u32 s32, s32, 4096
    s_add_u32 m0, s56, s43
    s_add_u32 s56, s56, 8192
    s_cmp_eq_u32 s56, 49152
    s_cselect_b32 s56, 0, s56
    buffer_load_dwordx4 v4, s[8:11], s32 offen lds
    buffer_load_dwordx4 v4, s[8:11], s32 offen offset:1024 lds
    s_add_u32 s32, s32, 4096
    s_waitcnt vmcnt(8)
    s_barrier
    s_mov_b32 s36, 4
L_ln2_10_0:
    s_add_u32 m0, s56, s43
    s_add_u32 s56, s56, 8192
    s_cmp_eq_u32 s56, 49152
    s_cselect_b32 s56, 0, s56
    buffer_load_dwordx4 v4, s[8:11], s32 offen lds
    buffer_load_dwordx4 v4, s[8:11], s32 offen offset:1024 lds
    s_add_u32 s32, s32, 4096
    s_waitcnt vmcnt(8)
    s_barrier
    s_sub_u32 s36, s36, 1
    s_cmp_lg_u32 s36, 0
    s_cbranch_scc1 L_ln2_10_0
    s_waitcnt vmcnt(6)
    s_barrier
    s_waitcnt vmcnt(4)
    s_barrier
    s_waitcnt vmcnt(2)
    s_barrier
    s_waitcnt vmcnt(0)
    s_barrier
    s_branch L_ln_done
L_ln_next_2_10:
    s_cmp_lt_u32 s100, 2
    s_cbranch_scc1 L_ln_next_2_27
    s_cmp_eq_u32 s55, 27
    s_cbranch_scc0 L_ln_next_2_27
    s_add_u32 m0, s56, s43
    s_add_u32 s56, s56, 8192
    s_cmp_eq_u32 s56, 49152
    s_cselect_b32 s56, 0, s56
    buffer_load_dwordx4 v4, s[8:11], s32 offen lds
    buffer_load_dwordx4 v4, s[8:11], s32 offen offset:1024 lds
    s_add_u32 s32, s32, 4096
    s_add_u32 m0, s56, s43
    s_add_u32 s56, s56, 8192
    s_cmp_eq_u32 s56, 49152
    s_cselect_b32 s56, 0, s56
    buffer_load_dwordx4 v4, s[8:11], s32 offen lds
    buffer_load_dwordx4 v4, s[8:11], s32 offen offset:1024 lds
    s_add_u32 s32, s32, 4096
    s_add_u32 m0, s56, s43
    s_add_u32 s56, s56, 8192
    s_cmp_eq_u32 s56, 49152
    s_cselect_b32 s56, 0, s56
    buffer_load_dwordx4 v4, s[8:11], s32 offen lds
    buffer_load_dwordx4 v4, s[8:11], s32 offen offset:1024 lds
    s_add_u32 s32, s32, 4096
    s_add_u32 m0, s56, s43
    s_add_u32 s56, s56, 8192
    s_cmp_eq_u32 s56, 49152
    s_cselect_b32 s56, 0, s56
    buffer_load_dwordx4 v4, s[8:11], s32 offen lds
    buffer_load_dwordx4 v4, s[8:11], s32 offen offset:1024 lds
    s_add_u32 s32, s32, 4096
    s_waitcnt vmcnt(6)
    s_barrier
    s_add_u32 m0, s56, s43
    s_add_u32 s56, s56, 8192
    s_cmp_eq_u32 s56, 49152
    s_cselect_b32 s56, 0, s56
    buffer_load_dwordx4 v4, s[8:11], s32 offen lds
    buffer_load_dwordx4 v4, s[8:11], s32 offen offset:1024 lds
    s_add_u32 s32, s32, 4096
    s_add_u32 m0, s56, s43
    s_add_u32 s56, s56, 8192
    s_cmp_eq_u32 s56, 49152
    s_cselect_b32 s56, 0, s56
    buffer_load_dwordx4 v4, s[8:11], s32 offen lds
    buffer_load_dwordx4 v4, s[8:11], s32 offen offset:1024 lds
    s_add_u32 s32, s32, 4096
    s_waitcnt vmcnt(8)
    s_barrier
    s_add_u32 m0, s56, s43
    s_add_u32 s56, s56, 8192
    s_cmp_eq_u32 s56, 49152
    s_cselect_b32 s56, 0, s56
    buffer_load_dwordx4 v4, s[8:11], s32 offen lds
    buffer_load_dwordx4 v4, s[8:11], s32 offen offset:1024 lds
    s_add_u32 s32, s32, 4096
    s_add_u32 m0, s34, s44
    s_add_u32 s34, s34, 10240
    s_cmp_eq_u32 s34, 102400
    s_cselect_b32 s34, 0, s34
    buffer_load_dwordx4 v4, s[12:15], s33 offen lds
    buffer_load_dwordx4 v4, s[12:15], s33 offen offset:1024 lds
    s_add_u32 s33, s33, 10240
    s_waitcnt vmcnt(10)
    s_barrier
    s_add_u32 m0, s56, s43
    s_add_u32 s56, s56, 8192
    s_cmp_eq_u32 s56, 49152
    s_cselect_b32 s56, 0, s56
    buffer_load_dwordx4 v4, s[8:11], s32 offen lds
    buffer_load_dwordx4 v4, s[8:11], s32 offen offset:1024 lds
    s_add_u32 s32, s32, 4096
    s_add_u32 m0, s34, s44
    s_add_u32 s34, s34, 10240
    s_cmp_eq_u32 s34, 102400
    s_cselect_b32 s34, 0, s34
    buffer_load_dwordx4 v4, s[12:15], s33 offen lds
    buffer_load_dwordx4 v4, s[12:15], s33 offen offset:1024 lds
    s_add_u32 s33, s33, 10240
    s_waitcnt vmcnt(12)
    s_barrier
    s_add_u32 m0, s56, s43
    s_add_u32 s56, s56, 8192
    s_cmp_eq_u32 s56, 49152
    s_cselect_b32 s56, 0, s56
    buffer_load_dwordx4 v4, s[8:11], s32 offen lds
    buffer_load_dwordx4 v4, s[8:11], s32 offen offset:1024 lds
    s_add_u32 s32, s32, 4096
    s_add_u32 m0, s34, s44
    s_add_u32 s34, s34, 10240
    s_cmp_eq_u32 s34, 102400
    s_cselect_b32 s34, 0, s34
    buffer_load_dwordx4 v4, s[12:15], s33 offen lds
    buffer_load_dwordx4 v4, s[12:15], s33 offen offset:1024 lds
    s_add_u32 s33, s33, 10240
    s_waitcnt vmcnt(14)
    s_barrier
    s_add_u32 m0, s56, s43
    s_add_u32 s56, s56, 8192
    s_cmp_eq_u32 s56, 49152
    s_cselect_b32 s56, 0, s56
    buffer_load_dwordx4 v4, s[8:11], s32 offen lds
    buffer_load_dwordx4 v4, s[8:11], s32 offen offset:1024 lds
    s_add_u32 s32, s32, 4096
    s_add_u32 m0, s34, s44
    s_add_u32 s34, s34, 10240
    s_cmp_eq_u32 s34, 102400
    s_cselect_b32 s34, 0, s34
    buffer_load_dwordx4 v4, s[12:15], s33 offen lds
    buffer_load_dwordx4 v4, s[12:15], s33 offen offset:1024 lds
    s_add_u32 s33, s33, 10240
    s_waitcnt vmcnt(16)
    s_barrier
    s_mov_b32 s36, 13
L_ln2_27_0:
    s_add_u32 m0, s56, s43
    s_add_u32 s56, s56, 8192
    s_cmp_eq_u32 s56, 49152
    s_cselect_b32 s56, 0, s56
    buffer_load_dwordx4 v4, s[8:11], s32 offen lds
    buffer_load_dwordx4 v4, s[8:11], s32 offen offset:1024 lds
    s_add_u32 s32, s32, 4096
    s_add_u32 m0, s34, s44
    s_add_u32 s34, s34, 10240
    s_cmp_eq_u32 s34, 102400
    s_cselect_b32 s34, 0, s34
    buffer_load_dwordx4 v4, s[12:15], s33 offen lds
    buffer_load_dwordx4 v4, s[12:15], s33 offen offset:1024 lds
    s_add_u32 s33, s33, 10240
    s_waitcnt vmcnt(18)
    s_barrier
    s_sub_u32 s36, s36, 1
    s_cmp_lg_u32 s36, 0
    s_cbranch_scc1 L_ln2_27_0
    s_add_u32 m0, s56, s43
    s_add_u32 s56, s56, 8192
    s_cmp_eq_u32 s56, 49152
    s_cselect_b32 s56, 0, s56
    buffer_load_dwordx4 v4, s[8:11], s32 offen lds
    buffer_load_dwordx4 v4, s[8:11], s32 offen offset:1024 lds
    s_add_u32 s32, s32, 4096
    s_waitcnt vmcnt(16)
    s_barrier
    s_add_u32 m0, s56, s43
    s_add_u32 s56, s56, 8192
    s_cmp_eq_u32 s56, 49152
    s_cselect_b32 s56, 0, s56
    buffer_load_dwordx4 v4, s[8:11], s32 offen lds
    buffer_load_dwordx4 v4, s[8:11], s32 offen offset:1024 lds
    s_add_u32 s32, s32, 4096
    s_waitcnt vmcnt(14)
    s_barrier
    s_add_u32 m0, s56, s43
    s_add_u32 s56, s56, 8192
    s_cmp_eq_u32 s56, 49152
    s_cselect_b32 s56, 0, s56
    buffer_load_dwordx4 v4, s[8:11], s32 offen lds
    buffer_load_dwordx4 v4, s[8:11], s32 offen offset:1024 lds
    s_add_u32 s32, s32, 4096
    s_waitcnt vmcnt(12)
    s_barrier
    s_add_u32 m0, s56, s43
    s_add_u32 s56, s56, 8192
    s_cmp_eq_u32 s56, 49152
    s_cselect_b32 s56, 0, s56
    buffer_load_dwordx4 v4, s[8:11], s32 offen lds
    buffer_load_dwordx4 v4, s[8:11], s32 offen offset:1024 lds
    s_add_u32 s32, s32, 4096
    s_waitcnt vmcnt(10)
    s_barrier
    s_waitcnt vmcnt(6)
    s_barrier
    s_waitcnt vmcnt(4)
    s_barrier
    s_waitcnt vmcnt(2)
    s_barrier
    s_waitcnt vmcnt(0)
    s_barrier
    s_branch L_ln_done
L_ln_next_2_27:
L_ln_done:
    s_barrier
    s_cmp_eq_u32 s55, 27
    s_cbranch_scc1 L_after_fb
    s_and_b32 s41, s2, 7
    s_lshr_b32 s42, s2, 3
    s_and_b32 s29, s41, 3
    s_lshl_b32 s29, s29, 2
    s_and_b32 s43, s42, 3
    s_add_u32 s29, s29, s43
    s_lshr_b32 s41, s41, 2
    s_lshr_b32 s42, s42, 2
    s_mul_i32 s30, s41, 7
    s_add_u32 s30, s30, s42
    s_cmp_ge_u32 s42, 7
    s_cbranch_scc1 L_o_fa_idle
    s_mov_b32 s31, 3
    s_mov_b32 s38, 3456
    s_mov_b32 s40, 6912
    s_lshl_b32 s39, s30, 7
    s_load_dwordx2 s[50:51], s[0:1], 32
    s_waitcnt lgkmcnt(0)
    v_lshlrev_b32 v4, 4, v1
    v_lshrrev_b32 v11, 4, v1
    v_lshlrev_b32 v5, 6, v11
    v_and_b32 v12, 3, v1
    v_lshlrev_b32 v12, 4, v12
    v_add_u32 v5, v5, v12
    v_bfe_u32 v12, v1, 2, 2
    v_mul_lo_u32 v12, v12, s38
    v_add_u32 v5, v5, v12
    s_cmp_eq_u32 s31, 3
    s_cselect_b32 s41, s30, 0
    s_cmp_eq_u32 s41, 13
    s_cselect_b32 s41, s101, 0
    v_cmp_le_u32 vcc, 2, v11
    v_mov_b32 v12, s41
    s_lshl_b32 s41, s38, 2
    s_sub_u32 s41, s41, 1024
    v_cndmask_b32 v12, 0, v12, vcc
    v_add_u32 v5, v5, v12
    v_add_u32 v6, s41, v5
    v_add_u32 v7, s41, v6
    v_add_u32 v8, s41, v7
    s_lshl_b32 s35, s38, 6
    s_lshl_b32 s41, s38, 4
    s_mul_i32 s41, s41, s100
    s_lshl_b32 s33, s39, 1
    s_add_u32 s33, s33, s41
    s_lshl_b32 s34, s100, 12
    s_mul_i32 s49, s38, 640
    s_mov_b32 s12, s50
    s_mov_b32 s13, s51
    s_mov_b32 s14, s49
    s_mov_b32 s15, 0x20000
    s_mov_b32 s36, 0
    s_mov_b32 s48, 0
    s_add_u32 m0, s36, s34
    s_add_u32 s36, s36, 16384
    s_cmp_eq_u32 s36, 98304
    s_cselect_b32 s36, 0, s36
    buffer_load_dwordx4 v5, s[12:15], s33 offen lds
    buffer_load_dwordx4 v6, s[12:15], s33 offen offset:1024 lds
    buffer_load_dwordx4 v7, s[12:15], s33 offen offset:2048 lds
    buffer_load_dwordx4 v8, s[12:15], s33 offen offset:3072 lds
    s_add_u32 s33, s33, s35
    s_add_u32 m0, s36, s34
    s_add_u32 s36, s36, 16384
    s_cmp_eq_u32 s36, 98304
    s_cselect_b32 s36, 0, s36
    buffer_load_dwordx4 v5, s[12:15], s33 offen lds
    buffer_load_dwordx4 v6, s[12:15], s33 offen offset:1024 lds
    buffer_load_dwordx4 v7, s[12:15], s33 offen offset:2048 lds
    buffer_load_dwordx4 v8, s[12:15], s33 offen offset:3072 lds
    s_add_u32 s33, s33, s35
    s_barrier
    s_add_u32 m0, s36, s34
    s_add_u32 s36, s36, 16384
    s_cmp_eq_u32 s36, 98304
    s_cselect_b32 s36, 0, s36
    buffer_load_dwordx4 v5, s[12:15], s33 offen lds
    buffer_load_dwordx4 v6, s[12:15], s33 offen offset:1024 lds
    buffer_load_dwordx4 v7, s[12:15], s33 offen offset:2048 lds
    buffer_load_dwordx4 v8, s[12:15], s33 offen offset:3072 lds
    s_add_u32 s33, s33, s35
    s_add_u32 m0, s36, s34
    s_add_u32 s36, s36, 16384
    s_cmp_eq_u32 s36, 98304
    s_cselect_b32 s36, 0, s36
    buffer_load_dwordx4 v5, s[12:15], s33 offen lds
    buffer_load_dwordx4 v6, s[12:15], s33 offen offset:1024 lds
    buffer_load_dwordx4 v7, s[12:15], s33 offen offset:2048 lds
    buffer_load_dwordx4 v8, s[12:15], s33 offen offset:3072 lds
    s_add_u32 s33, s33, s35
    s_add_u32 m0, s36, s34
    s_add_u32 s36, s36, 16384
    s_cmp_eq_u32 s36, 98304
    s_cselect_b32 s36, 0, s36
    buffer_load_dwordx4 v5, s[12:15], s33 offen lds
    buffer_load_dwordx4 v6, s[12:15], s33 offen offset:1024 lds
    buffer_load_dwordx4 v7, s[12:15], s33 offen offset:2048 lds
    buffer_load_dwordx4 v8, s[12:15], s33 offen offset:3072 lds
    s_add_u32 s33, s33, s35
    s_add_u32 m0, s36, s34
    s_add_u32 s36, s36, 16384
    s_cmp_eq_u32 s36, 98304
    s_cselect_b32 s36, 0, s36
    buffer_load_dwordx4 v5, s[12:15], s33 offen lds
    buffer_load_dwordx4 v6, s[12:15], s33 offen offset:1024 lds
    buffer_load_dwordx4 v7, s[12:15], s33 offen offset:2048 lds
    buffer_load_dwordx4 v8, s[12:15], s33 offen offset:3072 lds
    s_add_u32 s33, s33, s35
    s_branch L_WIDE
L_o_fa_idle:
    s_barrier
    s_and_b32 s37, s2, 7
    s_lshr_b32 s38, s2, 3
    s_and_b32 s29, s37, 3
    s_lshl_b32 s29, s29, 3
    s_and_b32 s39, s38, 7
    s_add_u32 s29, s29, s39
    s_lshr_b32 s37, s37, 2
    s_lshl_b32 s37, s37, 2
    s_lshr_b32 s38, s38, 3
    s_add_u32 s30, s37, s38
    s_mov_b32 s55, 27
    s_mov_b32 s45, 108
    v_lshlrev_b32 v4, 4, v1
    s_mov_b32 s37, 0xb40000
    s_mov_b32 s38, 819200
    s_cmp_eq_u32 s55, 27
    s_cselect_b32 s37, 0xc40000, s37
    s_cselect_b32 s38, 2211840, s38
    s_add_u32 s12, s4, s37
    s_addc_u32 s13, s5, 0
    s_mov_b32 s14, s38
    s_mov_b32 s15, 0x20000
    s_mul_i32 s37, s100, 3072
    s_cmp_eq_u32 s100, 3
    s_cselect_b32 s37, 8192, s37
    s_add_u32 s44, s37, 49152
    s_lshl_b32 s38, s45, 2
    s_mul_i32 s38, s38, 640
    s_mul_i32 s38, s38, s30
    s_add_u32 s33, s38, s37
    s_mov_b32 s34, 0
    s_mov_b32 s56, 0
    s_and_b32 s40, s100, 1
    s_lshr_b32 s41, s100, 1
    s_lshl_b32 s43, s40, 12
    s_lshl_b32 s38, s41, 11
    s_add_u32 s43, s43, s38
    s_cmp_lt_u32 s100, 2
    s_cbranch_scc0 L_lnpfs_fb2_3
    s_mov_b32 s36, 10
L_lnpf_fb2_3:
    s_add_u32 m0, s34, s44
    s_add_u32 s34, s34, 10240
    s_cmp_eq_u32 s34, 102400
    s_cselect_b32 s34, 0, s34
    buffer_load_dwordx4 v4, s[12:15], s33 offen lds
    buffer_load_dwordx4 v4, s[12:15], s33 offen offset:1024 lds
    buffer_load_dwordx4 v4, s[12:15], s33 offen offset:2048 lds
    s_add_u32 s33, s33, 10240
    s_sub_u32 s36, s36, 1
    s_cmp_lg_u32 s36, 0
    s_cbranch_scc1 L_lnpf_fb2_3
L_lnpfs_fb2_3:
    s_cmp_lt_u32 s100, 2
    s_cbranch_scc1 L_lnpfs_fb2_2
    s_mov_b32 s36, 10
L_lnpf_fb2_2:
    s_add_u32 m0, s34, s44
    s_add_u32 s34, s34, 10240
    s_cmp_eq_u32 s34, 102400
    s_cselect_b32 s34, 0, s34
    buffer_load_dwordx4 v4, s[12:15], s33 offen lds
    buffer_load_dwordx4 v4, s[12:15], s33 offen offset:1024 lds
    s_add_u32 s33, s33, 10240
    s_sub_u32 s36, s36, 1
    s_cmp_lg_u32 s36, 0
    s_cbranch_scc1 L_lnpf_fb2_2
L_lnpfs_fb2_2:
    s_branch L_NARROW
L_after_fb:
    s_cmp_eq_u32 s7, 1
    s_cbranch_scc1 L_end
    s_mov_b32 s7, 1
    s_and_b32 s41, s2, 7
    s_lshr_b32 s42, s2, 3
    s_and_b32 s29, s41, 3
    s_lshl_b32 s29, s29, 2
    s_and_b32 s43, s42, 3
    s_add_u32 s29, s29, s43
    s_lshr_b32 s41, s41, 2
    s_lshr_b32 s42, s42, 2
    s_lshl_b32 s30, s41, 3
    s_add_u32 s30, s30, s42
    s_cmp_ge_u32 s30, 15
    s_cbranch_scc1 L_fb_qkv_idle
    s_cmp_ge_u32 s30, 5
    s_cselect_b32 s31, 1, 0
    s_cmp_ge_u32 s30, 10
    s_cselect_b32 s31, 2, s31
    s_mov_b32 s38, 3840
    s_mov_b32 s40, 7680
    s_lshl_b32 s39, s30, 7
    s_load_dwordx2 s[50:51], s[0:1], 8
    s_waitcnt lgkmcnt(0)
    v_lshlrev_b32 v4, 4, v1
    v_lshrrev_b32 v11, 4, v1
    v_lshlrev_b32 v5, 6, v11
    v_and_b32 v12, 3, v1
    v_lshlrev_b32 v12, 4, v12
    v_add_u32 v5, v5, v12
    v_bfe_u32 v12, v1, 2, 2
    v_mul_lo_u32 v12, v12, s38
    v_add_u32 v5, v5, v12
    s_cmp_eq_u32 s31, 3
    s_cselect_b32 s41, s30, 0
    s_cmp_eq_u32 s41, 13
    s_cselect_b32 s41, s101, 0
    v_cmp_le_u32 vcc, 2, v11
    v_mov_b32 v12, s41
    s_lshl_b32 s41, s38, 2
    s_sub_u32 s41, s41, 1024
    v_cndmask_b32 v12, 0, v12, vcc
    v_add_u32 v5, v5, v12
    v_add_u32 v6, s41, v5
    v_add_u32 v7, s41, v6
    v_add_u32 v8, s41, v7
    s_lshl_b32 s35, s38, 6
    s_lshl_b32 s41, s38, 4
    s_mul_i32 s41, s41, s100
    s_lshl_b32 s33, s39, 1
    s_add_u32 s33, s33, s41
    s_lshl_b32 s34, s100, 12
    s_mul_i32 s49, s38, 640
    s_mov_b32 s12, s50
    s_mov_b32 s13, s51
    s_mov_b32 s14, s49
    s_mov_b32 s15, 0x20000
    s_mov_b32 s36, 0
    s_mov_b32 s48, 0
    s_add_u32 m0, s36, s34
    s_add_u32 s36, s36, 16384
    s_cmp_eq_u32 s36, 98304
    s_cselect_b32 s36, 0, s36
    buffer_load_dwordx4 v5, s[12:15], s33 offen lds
    buffer_load_dwordx4 v6, s[12:15], s33 offen offset:1024 lds
    buffer_load_dwordx4 v7, s[12:15], s33 offen offset:2048 lds
    buffer_load_dwordx4 v8, s[12:15], s33 offen offset:3072 lds
    s_add_u32 s33, s33, s35
    s_add_u32 m0, s36, s34
    s_add_u32 s36, s36, 16384
    s_cmp_eq_u32 s36, 98304
    s_cselect_b32 s36, 0, s36
    buffer_load_dwordx4 v5, s[12:15], s33 offen lds
    buffer_load_dwordx4 v6, s[12:15], s33 offen offset:1024 lds
    buffer_load_dwordx4 v7, s[12:15], s33 offen offset:2048 lds
    buffer_load_dwordx4 v8, s[12:15], s33 offen offset:3072 lds
    s_add_u32 s33, s33, s35
    s_barrier
    s_add_u32 m0, s36, s34
    s_add_u32 s36, s36, 16384
    s_cmp_eq_u32 s36, 98304
    s_cselect_b32 s36, 0, s36
    buffer_load_dwordx4 v5, s[12:15], s33 offen lds
    buffer_load_dwordx4 v6, s[12:15], s33 offen offset:1024 lds
    buffer_load_dwordx4 v7, s[12:15], s33 offen offset:2048 lds
    buffer_load_dwordx4 v8, s[12:15], s33 offen offset:3072 lds
    s_add_u32 s33, s33, s35
    s_add_u32 m0, s36, s34
    s_add_u32 s36, s36, 16384
    s_cmp_eq_u32 s36, 98304
    s_cselect_b32 s36, 0, s36
    buffer_load_dwordx4 v5, s[12:15], s33 offen lds
    buffer_load_dwordx4 v6, s[12:15], s33 offen offset:1024 lds
    buffer_load_dwordx4 v7, s[12:15], s33 offen offset:2048 lds
    buffer_load_dwordx4 v8, s[12:15], s33 offen offset:3072 lds
    s_add_u32 s33, s33, s35
    s_add_u32 m0, s36, s34
    s_add_u32 s36, s36, 16384
    s_cmp_eq_u32 s36, 98304
    s_cselect_b32 s36, 0, s36
    buffer_load_dwordx4 v5, s[12:15], s33 offen lds
    buffer_load_dwordx4 v6, s[12:15], s33 offen offset:1024 lds
    buffer_load_dwordx4 v7, s[12:15], s33 offen offset:2048 lds
    buffer_load_dwordx4 v8, s[12:15], s33 offen offset:3072 lds
    s_add_u32 s33, s33, s35
    s_add_u32 m0, s36, s34
    s_add_u32 s36, s36, 16384
    s_cmp_eq_u32 s36, 98304
    s_cselect_b32 s36, 0, s36
    buffer_load_dwordx4 v5, s[12:15], s33 offen lds
    buffer_load_dwordx4 v6, s[12:15], s33 offen offset:1024 lds
    buffer_load_dwordx4 v7, s[12:15], s33 offen offset:2048 lds
    buffer_load_dwordx4 v8, s[12:15], s33 offen offset:3072 lds
    s_add_u32 s33, s33, s35
    s_branch L_WIDE
L_fb_qkv_idle:
    s_barrier
    s_branch L_ATT
L_end:
    s_endpgm
L_code_end:
.section .rodata,"a"
.p2align 6
.amdhsa_kernel interleave_layers__mha_block__dense_activation_silu__prompt_kernel
  .amdhsa_next_free_vgpr 256
  .amdhsa_next_free_sgpr 102
  .amdhsa_accum_offset 256
  .amdhsa_group_segment_fixed_size 0
  .amdhsa_kernarg_size 72
  .amdhsa_user_sgpr_count 2
  .amdhsa_user_sgpr_kernarg_segment_ptr 1
  .amdhsa_system_sgpr_workgroup_id_x 1
  .amdhsa_float_denorm_mode_32 3
.end_amdhsa_kernel
.text
```
